```python
import torch

def _softmax(x, axis=-1):
    return torch.softmax(x, dim=axis)
def _gelu(x):
    return torch.nn.functional.gelu(x, approximate="tanh")
def _silu(x):
    return torch.nn.functional.silu(x)
def _sigmoid(x):
    return torch.sigmoid(x)
def _layernorm(x, axis=-1, eps=1e-5):
    m = x.mean(dim=axis, keepdim=True)
    v = x.var(dim=axis, keepdim=True, unbiased=False)
    return (x - m) / torch.sqrt(v + eps)
def _scatter_add(tgt, idx, src, axis=0):
    return tgt.clone().index_add_(axis, idx, src)
def _segment_sum(src, seg, n):
    out = torch.zeros((n,) + src.shape[1:], dtype=src.dtype)
    return out.index_add_(0, seg, src)
def _pad(x, pw):
    flat = tuple(v for pair in reversed(pw) for v in pair)
    return torch.nn.functional.pad(x, flat)

kernel_name = 'concat_heads__linear_attn_block__ssm_conv_s5__prompt'

def setup_inputs():

    _w = (lambda a: (lambda t: t.to(torch.bfloat16) if t.is_floating_point() else t)(torch.as_tensor(a)))
    def _A_setup():
        B, S, D = 1, 2048, 512
        return {
            "x": _w((lambda *s: torch.randn(*s, dtype=torch.bfloat16) * 0.05)(B, S, D)),
            "wqkv": _w((lambda *s: torch.randn(*s, dtype=torch.bfloat16) * 0.4)(D, 3 * D)),
            "wo": _w((lambda *s: torch.randn(*s, dtype=torch.bfloat16) * 0.05)(D, D)),
        }
    _A_in = _A_setup()

    def _B_setup():
        B, S, D = 1, 2048, 512
        P = D
        Lambda_re = -0.5 * (lambda _x: torch.exp(torch.as_tensor(_x)))((lambda *s: torch.randn(*s, dtype=torch.bfloat16) * 0.2)(P))
        Lambda_im = (lambda *s: torch.randn(*s, dtype=torch.bfloat16) * 0.8)(P) * 1.0
        B_re = (lambda *s: torch.randn(*s, dtype=torch.bfloat16) * 0.2)(P, D) * (D ** -0.5)
        B_im = (lambda *s: torch.randn(*s, dtype=torch.bfloat16) * 0.2)(P, D) * (D ** -0.5)
        C_re = (lambda *s: torch.randn(*s, dtype=torch.bfloat16) * 0.2)(D, P) * (P ** -0.5)
        C_im = (lambda *s: torch.randn(*s, dtype=torch.bfloat16) * 0.2)(D, P) * (P ** -0.5)
        log_dt = (lambda *s: torch.randn(*s, dtype=torch.bfloat16) * 0.2)(P) * 0.3 - 2.0
        Dskip = (lambda *s: torch.randn(*s, dtype=torch.bfloat16) * 0.05)(D)
        return {
            "x": _w((lambda *s: torch.randn(*s, dtype=torch.bfloat16) * 0.05)(B, S, D)),
            "Lambda_re": _w(Lambda_re),
            "Lambda_im": _w(Lambda_im),
            "B_re": _w(B_re),
            "B_im": _w(B_im),
            "C_re": _w(C_re),
            "C_im": _w(C_im),
            "log_dt": _w(log_dt),
            "Dskip": _w(Dskip),
        }
    _B_in = _B_setup()

    return {
        "A_x": _A_in["x"],
        "A_wqkv": _A_in["wqkv"],
        "A_wo": _A_in["wo"],
        "B_x": _B_in["x"],
        "B_Lambda_re": _B_in["Lambda_re"],
        "B_Lambda_im": _B_in["Lambda_im"],
        "B_B_re": _B_in["B_re"],
        "B_B_im": _B_in["B_im"],
        "B_C_re": _B_in["C_re"],
        "B_C_im": _B_in["C_im"],
        "B_log_dt": _B_in["log_dt"],
        "B_Dskip": _B_in["Dskip"],
    }

def reference(A_x, A_wqkv, A_wo, B_x, B_Lambda_re, B_Lambda_im, B_B_re, B_B_im, B_C_re, B_C_im, B_log_dt, B_Dskip):
    def _A_ref(x, wqkv, wo):
        B, S, D = x.shape
        H = 32; Dh = D // H
        qkv = (lambda x, *d: x.permute(*d))((x @ wqkv).reshape(B, S, 3, H, Dh), 2, 0, 3, 1, 4)
        q, k, v = qkv[0], qkv[1], qkv[2]
        phi = lambda t: torch.where(t > 0, t + 1, torch.exp(t)) + 1e-6
        pq, pk = phi(q), phi(k)
        kv = torch.einsum("bhsd,bhse->bhde", pk, v)
        z = torch.einsum("bhsd->bhd", pk)
        num = torch.einsum("bhqd,bhde->bhqe", pq, kv)
        den = torch.einsum("bhqd,bhd->bhq", pq, z)[..., None] + 1e-6
        o = num / den
        return (lambda x, *d: x.permute(*d))(o, 0, 2, 1, 3).reshape(B, S, D) @ wo

    def _B_ref(x, Lambda_re, Lambda_im, B_re, B_im, C_re, C_im, log_dt, Dskip):
        Bsz, L, H = x.shape
        Lam = Lambda_re + 1j * Lambda_im
        Bmat = B_re + 1j * B_im
        Cmat = C_re + 1j * C_im
        dt = torch.exp(log_dt)
        Lam_bar = torch.exp(dt * Lam)
        B_bar = ((Lam_bar - 1.0) / Lam)[:, None] * Bmat
        Bu = torch.einsum("bld,pd->blp", x + 0j, B_bar)
        h = torch.zeros_like(Bu[:, 0, :])
        hs = []
        for t in range(L):
            h = Lam_bar[None, :] * h + Bu[:, t, :]
            hs.append(h)
        hseq = torch.stack(hs, 1)
        y = 2.0 * torch.einsum("blp,dp->bld", hseq, Cmat).real + x * Dskip[None, None, :]
        return y

    a = _A_ref(A_x, A_wqkv, A_wo)
    b = _B_ref(B_x, B_Lambda_re, B_Lambda_im, B_B_re, B_B_im, B_C_re, B_C_im, B_log_dt, B_Dskip)
    return torch.concatenate([a, b], axis=-1)
```

```asm
; @launch grid=(256,1,1) block=(512,1,1) lds=163840
.amdgcn_target "amdgcn-amd-amdhsa--gfx950"

.text
.globl concat_heads__linear_attn_block__ssm_conv_s5__prompt_kernel
.p2align 8
.type concat_heads__linear_attn_block__ssm_conv_s5__prompt_kernel,@function
concat_heads__linear_attn_block__ssm_conv_s5__prompt_kernel:
concat_heads__linear_attn_block__ssm_conv_s5__prompt_kernel_start:
    s_cmp_ge_u32 s2, 256
    s_cbranch_scc1 concat_heads__linear_attn_block__ssm_conv_s5__prompt_kernel_end
    s_load_dwordx4 s[4:7], s[0:1], 0
    s_load_dwordx4 s[8:11], s[0:1], 16
    s_load_dwordx4 s[16:19], s[0:1], 48
    s_getpc_b64 s[64:65]
concat_heads__linear_attn_block__ssm_conv_s5__prompt_kernel_pcref:
    s_lshr_b32 s66, s2, 3
    s_mul_i32 s66, s66, 9
    v_add_u32 v2, s66, v0
    v_lshlrev_b32 v2, 7, v2
    v_min_u32 v2, concat_heads__linear_attn_block__ssm_conv_s5__prompt_kernel_end-concat_heads__linear_attn_block__ssm_conv_s5__prompt_kernel_pcref, v2
    v_cmp_gt_u32 vcc, 9, v0
    s_and_saveexec_b64 s[66:67], vcc
    s_cbranch_execz concat_heads__linear_attn_block__ssm_conv_s5__prompt_kernel_nocode
    global_load_dword v255, v2, s[64:65]
concat_heads__linear_attn_block__ssm_conv_s5__prompt_kernel_nocode:
    s_mov_b64 exec, s[66:67]
    v_lshrrev_b32 v1, 6, v0
    v_and_b32 v0, 63, v0
    v_readfirstlane_b32 s34, v1
    s_and_b32 s35, s2, 7
    s_lshr_b32 s36, s2, 3
    s_and_b32 s64, s35, 3
    s_lshl_b32 s37, s64, 2
    s_and_b32 s65, s36, 3
    s_add_u32 s37, s37, s65
    s_lshr_b32 s38, s36, 2
    s_add_u32 s39, s38, s65
    s_and_b32 s39, s39, 3
    s_lshl_b32 s39, s39, 1
    s_and_b32 s3, s34, 3
    s_cmp_lt_u32 s34, 4
    s_cbranch_scc1 concat_heads__linear_attn_block__ssm_conv_s5__prompt_kernel_compute
    v_lshrrev_b32 v5, 3, v0
    v_and_b32 v6, 7, v0
    v_lshrrev_b32 v7, 4, v0
    v_xor_b32 v8, v6, v7
    v_lshlrev_b32 v8, 4, v8
    v_lshlrev_b32 v2, 10, v5
    v_add_u32 v2, v2, v8
    v_xor_b32 v3, 64, v2
    s_lshl_b32 s70, s3, 12
    s_cmp_ge_u32 s35, 4
    s_cbranch_scc1 concat_heads__linear_attn_block__ssm_conv_s5__prompt_kernel_pro_b
    v_and_b32 v9, 1, v7
    v_lshlrev_b32 v9, 2, v9
    v_xor_b32 v9, v6, v9
    v_lshlrev_b32 v9, 4, v9
    v_mul_u32_u24 v4, 3072, v5
    v_add_u32 v4, v4, v9
    v_lshlrev_b32 v12, 10, v5
    v_add_u32 v12, v12, v9
    v_mov_b32 v20, v2
    v_mov_b32 v21, v3
    v_mov_b32 v22, v4
    v_mov_b32 v23, v4
    v_mov_b32 v11, v3
    s_lshl_b32 s64, s37, 7
    s_lshl_b32 s65, s3, 5
    s_add_u32 s64, s64, s65
    s_lshl_b32 s68, s64, 10
    s_mul_i32 s69, s3, 49152
    s_lshl_b32 s65, s38, 7
    s_add_u32 s69, s69, s65
    s_mov_b32 s76, 196608
    s_lshr_b32 s71, s70, 1
    s_movk_i32 s52, 0x2000
    s_movk_i32 s53, 0x4000
    s_movk_i32 s56, 0x2000
    s_movk_i32 s60, 1024
    s_movk_i32 s61, 25600
    s_movk_i32 s62, 2048
    s_movk_i32 s63, 26624
    s_waitcnt lgkmcnt(0)
    s_mov_b32 s40, s4
    s_and_b32 s41, s5, 0xffff
    s_mov_b32 s42, 0x200000
    s_mov_b32 s43, 0x20000
    s_mov_b32 s44, s6
    s_and_b32 s45, s7, 0xffff
    s_mov_b32 s46, 0x180000
    s_mov_b32 s47, 0x20000
    s_branch concat_heads__linear_attn_block__ssm_conv_s5__prompt_kernel_pro_j
concat_heads__linear_attn_block__ssm_conv_s5__prompt_kernel_pro_b:
    v_lshrrev_b32 v9, 5, v0
    v_lshlrev_b32 v9, 5, v9
    v_and_b32 v10, 1, v5
    v_lshlrev_b32 v10, 4, v10
    v_add_u32 v9, v9, v10
    v_and_b32 v10, 1, v7
    v_add_u32 v9, v9, v10
    v_lshlrev_b32 v4, 10, v9
    v_add_u32 v4, v4, v8
    v_xor_b32 v11, 64, v4
    v_mov_b32 v20, v4
    v_mov_b32 v21, v11
    v_mov_b32 v22, v2
    v_mov_b32 v23, v3
    v_mov_b32 v12, v2
    s_lshl_b32 s64, s37, 7
    s_lshl_b32 s65, s3, 2
    s_add_u32 s64, s64, s65
    s_lshl_b32 s68, s64, 10
    s_lshl_b32 s64, s38, 6
    s_and_b32 s65, s3, 1
    s_lshl_b32 s65, s65, 5
    s_add_u32 s64, s64, s65
    s_lshl_b32 s69, s64, 10
    s_movk_i32 s76, 128
    s_mov_b32 s71, s70
    s_mov_b32 s52, 0x10000
    s_movk_i32 s53, 0x800
    s_movk_i32 s56, 0x800
    s_movk_i32 s60, 0
    s_movk_i32 s61, 0x2000
    s_movk_i32 s62, 0x4000
    s_movk_i32 s63, 0x6000
    s_waitcnt lgkmcnt(0)
    s_mov_b32 s40, s10
    s_and_b32 s41, s11, 0xffff
    s_mov_b32 s42, 0x200000
    s_mov_b32 s43, 0x20000
    s_cmp_lt_u32 s3, 2
    s_cselect_b32 s64, s16, s18
    s_cselect_b32 s65, s17, s19
    s_mov_b32 s44, s64
    s_and_b32 s45, s65, 0xffff
    s_mov_b32 s46, 0x80000
    s_mov_b32 s47, 0x20000
concat_heads__linear_attn_block__ssm_conv_s5__prompt_kernel_pro_j:
    s_add_u32 s54, s52, s53
    s_add_u32 s57, s56, 1024
    s_add_u32 s64, s39, 0
    s_and_b32 s64, s64, 7
    s_lshl_b32 s65, s64, 7
    s_add_u32 s65, s65, s68
    s_mul_i32 s66, s64, s76
    s_add_u32 s66, s66, s69
    s_add_u32 m0, s70, 0
    s_mov_b32 s67, s65
    buffer_load_dwordx4 v20, s[40:43], s67 offen lds
    s_add_u32 m0, s70, 1024
    s_add_u32 s67, s65, s52
    buffer_load_dwordx4 v21, s[40:43], s67 offen lds
    s_add_u32 m0, s70, 2048
    s_add_u32 s67, s65, s53
    buffer_load_dwordx4 v20, s[40:43], s67 offen lds
    s_add_u32 m0, s70, 3072
    s_add_u32 s67, s65, s54
    buffer_load_dwordx4 v21, s[40:43], s67 offen lds
    s_add_u32 s72, s71, 16384
    s_add_u32 m0, s72, 0
    s_add_u32 s67, s66, s60
    buffer_load_dwordx4 v22, s[44:47], s67 offen lds
    s_add_u32 m0, s72, 1024
    s_add_u32 s67, s66, s61
    buffer_load_dwordx4 v23, s[44:47], s67 offen lds
    s_add_u32 m0, s72, s56
    s_add_u32 s67, s66, s62
    buffer_load_dwordx4 v22, s[44:47], s67 offen lds
    s_add_u32 m0, s72, s57
    s_add_u32 s67, s66, s63
    buffer_load_dwordx4 v23, s[44:47], s67 offen lds
    s_add_u32 s64, s39, 1
    s_and_b32 s64, s64, 7
    s_lshl_b32 s65, s64, 7
    s_add_u32 s65, s65, s68
    s_mul_i32 s66, s64, s76
    s_add_u32 s66, s66, s69
    s_add_u32 m0, s70, 32768
    s_mov_b32 s67, s65
    buffer_load_dwordx4 v20, s[40:43], s67 offen lds
    s_add_u32 m0, s70, 33792
    s_add_u32 s67, s65, s52
    buffer_load_dwordx4 v21, s[40:43], s67 offen lds
    s_add_u32 m0, s70, 34816
    s_add_u32 s67, s65, s53
    buffer_load_dwordx4 v20, s[40:43], s67 offen lds
    s_add_u32 m0, s70, 35840
    s_add_u32 s67, s65, s54
    buffer_load_dwordx4 v21, s[40:43], s67 offen lds
    s_add_u32 s72, s71, 49152
    s_add_u32 m0, s72, 0
    s_add_u32 s67, s66, s60
    buffer_load_dwordx4 v22, s[44:47], s67 offen lds
    s_add_u32 m0, s72, 1024
    s_add_u32 s67, s66, s61
    buffer_load_dwordx4 v23, s[44:47], s67 offen lds
    s_add_u32 m0, s72, s56
    s_add_u32 s67, s66, s62
    buffer_load_dwordx4 v22, s[44:47], s67 offen lds
    s_add_u32 m0, s72, s57
    s_add_u32 s67, s66, s63
    buffer_load_dwordx4 v23, s[44:47], s67 offen lds
    s_load_dwordx4 s[12:15], s[0:1], 32
    s_load_dwordx4 s[20:23], s[0:1], 64
    s_load_dwordx4 s[24:27], s[0:1], 80
    s_load_dwordx4 s[28:31], s[0:1], 96
    s_load_dwordx2 s[32:33], s[0:1], 112
    s_cmp_ge_u32 s35, 4
    s_cbranch_scc1 concat_heads__linear_attn_block__ssm_conv_s5__prompt_kernel_bu_load
    s_waitcnt lgkmcnt(0)
    s_mov_b32 s48, s32
    s_and_b32 s49, s33, 0xffff
    s_mov_b32 s50, 0x10000000
    s_mov_b32 s51, 0x20000
    s_waitcnt vmcnt(8)
    s_barrier
    s_add_u32 s64, s39, 2
    s_and_b32 s64, s64, 7
    s_lshl_b32 s65, s64, 7
    s_add_u32 s65, s65, s68
    s_mul_i32 s66, s64, 196608
    s_add_u32 s66, s66, s69
    s_add_u32 m0, s70, 65536
    s_add_u32 s67, s65, 0
    buffer_load_dwordx4 v2, s[40:43], s67 offen lds
    s_add_u32 m0, s70, 66560
    s_add_u32 s67, s65, 8192
    buffer_load_dwordx4 v3, s[40:43], s67 offen lds
    s_add_u32 m0, s70, 67584
    s_add_u32 s67, s65, 16384
    buffer_load_dwordx4 v2, s[40:43], s67 offen lds
    s_add_u32 m0, s70, 68608
    s_add_u32 s67, s65, 24576
    buffer_load_dwordx4 v3, s[40:43], s67 offen lds
    s_lshr_b32 s71, s70, 1
    s_add_u32 m0, s71, 81920
    s_add_u32 s67, s66, 1024
    buffer_load_dwordx4 v4, s[44:47], s67 offen lds
    s_add_u32 m0, s71, 82944
    s_add_u32 s67, s66, 25600
    buffer_load_dwordx4 v4, s[44:47], s67 offen lds
    s_add_u32 m0, s71, 90112
    s_add_u32 s67, s66, 2048
    buffer_load_dwordx4 v4, s[44:47], s67 offen lds
    s_add_u32 m0, s71, 91136
    s_add_u32 s67, s66, 26624
    buffer_load_dwordx4 v4, s[44:47], s67 offen lds
    s_waitcnt vmcnt(8)
    s_barrier
    s_add_u32 s64, s39, 3
    s_and_b32 s64, s64, 7
    s_lshl_b32 s65, s64, 7
    s_add_u32 s65, s65, s68
    s_mul_i32 s66, s64, 196608
    s_add_u32 s66, s66, s69
    s_add_u32 m0, s70, 98304
    s_add_u32 s67, s65, 0
    buffer_load_dwordx4 v2, s[40:43], s67 offen lds
    s_add_u32 m0, s70, 99328
    s_add_u32 s67, s65, 8192
    buffer_load_dwordx4 v3, s[40:43], s67 offen lds
    s_add_u32 m0, s70, 100352
    s_add_u32 s67, s65, 16384
    buffer_load_dwordx4 v2, s[40:43], s67 offen lds
    s_add_u32 m0, s70, 101376
    s_add_u32 s67, s65, 24576
    buffer_load_dwordx4 v3, s[40:43], s67 offen lds
    s_lshr_b32 s71, s70, 1
    s_add_u32 m0, s71, 114688
    s_add_u32 s67, s66, 1024
    buffer_load_dwordx4 v4, s[44:47], s67 offen lds
    s_add_u32 m0, s71, 115712
    s_add_u32 s67, s66, 25600
    buffer_load_dwordx4 v4, s[44:47], s67 offen lds
    s_add_u32 m0, s71, 122880
    s_add_u32 s67, s66, 2048
    buffer_load_dwordx4 v4, s[44:47], s67 offen lds
    s_add_u32 m0, s71, 123904
    s_add_u32 s67, s66, 26624
    buffer_load_dwordx4 v4, s[44:47], s67 offen lds
    s_waitcnt vmcnt(8)
    s_barrier
    s_add_u32 s64, s39, 4
    s_and_b32 s64, s64, 7
    s_lshl_b32 s65, s64, 7
    s_add_u32 s65, s65, s68
    s_mul_i32 s66, s64, 196608
    s_add_u32 s66, s66, s69
    s_add_u32 m0, s70, 131072
    s_add_u32 s67, s65, 0
    buffer_load_dwordx4 v2, s[40:43], s67 offen lds
    s_add_u32 m0, s70, 132096
    s_add_u32 s67, s65, 8192
    buffer_load_dwordx4 v3, s[40:43], s67 offen lds
    s_add_u32 m0, s70, 133120
    s_add_u32 s67, s65, 16384
    buffer_load_dwordx4 v2, s[40:43], s67 offen lds
    s_add_u32 m0, s70, 134144
    s_add_u32 s67, s65, 24576
    buffer_load_dwordx4 v3, s[40:43], s67 offen lds
    s_lshr_b32 s71, s70, 1
    s_add_u32 m0, s71, 147456
    s_add_u32 s67, s66, 1024
    buffer_load_dwordx4 v4, s[44:47], s67 offen lds
    s_add_u32 m0, s71, 148480
    s_add_u32 s67, s66, 25600
    buffer_load_dwordx4 v4, s[44:47], s67 offen lds
    s_add_u32 m0, s71, 155648
    s_add_u32 s67, s66, 2048
    buffer_load_dwordx4 v4, s[44:47], s67 offen lds
    s_add_u32 m0, s71, 156672
    s_add_u32 s67, s66, 26624
    buffer_load_dwordx4 v4, s[44:47], s67 offen lds
    s_load_dwordx2 s[78:79], s[30:31], 128
    s_waitcnt vmcnt(8)
    s_barrier
    s_add_u32 s64, s39, 5
    s_and_b32 s64, s64, 7
    s_lshl_b32 s65, s64, 7
    s_add_u32 s65, s65, s68
    s_mul_i32 s66, s64, 196608
    s_add_u32 s66, s66, s69
    s_add_u32 m0, s70, 0
    s_add_u32 s67, s65, 0
    buffer_load_dwordx4 v2, s[40:43], s67 offen lds
    s_add_u32 m0, s70, 1024
    s_add_u32 s67, s65, 8192
    buffer_load_dwordx4 v3, s[40:43], s67 offen lds
    s_add_u32 m0, s70, 2048
    s_add_u32 s67, s65, 16384
    buffer_load_dwordx4 v2, s[40:43], s67 offen lds
    s_add_u32 m0, s70, 3072
    s_add_u32 s67, s65, 24576
    buffer_load_dwordx4 v3, s[40:43], s67 offen lds
    s_lshr_b32 s71, s70, 1
    s_add_u32 m0, s71, 16384
    s_add_u32 s67, s66, 1024
    buffer_load_dwordx4 v4, s[44:47], s67 offen lds
    s_add_u32 m0, s71, 17408
    s_add_u32 s67, s66, 25600
    buffer_load_dwordx4 v4, s[44:47], s67 offen lds
    s_add_u32 m0, s71, 24576
    s_add_u32 s67, s66, 2048
    buffer_load_dwordx4 v4, s[44:47], s67 offen lds
    s_add_u32 m0, s71, 25600
    s_add_u32 s67, s66, 26624
    buffer_load_dwordx4 v4, s[44:47], s67 offen lds
    s_waitcnt vmcnt(8)
    s_waitcnt lgkmcnt(0)
    s_cmp_lg_u32 s78, 0
    s_cbranch_scc1 concat_heads__linear_attn_block__ssm_conv_s5__prompt_kernel_nok_qkv
    s_mov_b32 s52, s30
    s_and_b32 s53, s31, 0xffff
    s_mov_b32 s54, 0x100
    s_mov_b32 s55, 0x20000
    s_mov_b32 s72, 262144
    v_mov_b32 v13, 0
concat_heads__linear_attn_block__ssm_conv_s5__prompt_kernel_nlp_qkv:
    buffer_load_dwordx2 v[14:15], v13, s[52:55], 0 offen offset:128 sc1
    s_waitcnt vmcnt(0)
    v_readfirstlane_b32 s78, v14
    v_readfirstlane_b32 s79, v15
    s_nop 3
    s_sub_u32 s72, s72, 1
    s_cbranch_scc1 concat_heads__linear_attn_block__ssm_conv_s5__prompt_kernel_nok_qkv
    s_cmp_lg_u32 s78, 0
    s_cbranch_scc1 concat_heads__linear_attn_block__ssm_conv_s5__prompt_kernel_nok_qkv
    s_sleep 2
    s_branch concat_heads__linear_attn_block__ssm_conv_s5__prompt_kernel_nlp_qkv
concat_heads__linear_attn_block__ssm_conv_s5__prompt_kernel_nok_qkv:
    s_add_u32 s64, s37, 0
    s_lshl_b32 s64, s64, 7
    s_add_u32 s64, s64, 7733248
    s_lshl_b32 s65, s38, 4
    s_add_u32 s64, s64, s65
    s_getreg_b32 s65, hwreg(HW_REG_XCC_ID, 0, 4)
    v_mov_b32 v16, s78
    v_mov_b32 v17, s79
    v_mov_b32 v18, s65
    v_mov_b32 v19, 0
    v_mov_b32 v13, 0
    buffer_store_dwordx4 v[16:19], v13, s[48:51], s64 offen sc1
    s_barrier
    s_add_u32 s64, s39, 6
    s_and_b32 s64, s64, 7
    s_lshl_b32 s65, s64, 7
    s_add_u32 s65, s65, s68
    s_mul_i32 s66, s64, 196608
    s_add_u32 s66, s66, s69
    s_add_u32 m0, s70, 32768
    s_add_u32 s67, s65, 0
    buffer_load_dwordx4 v2, s[40:43], s67 offen lds
    s_add_u32 m0, s70, 33792
    s_add_u32 s67, s65, 8192
    buffer_load_dwordx4 v3, s[40:43], s67 offen lds
    s_add_u32 m0, s70, 34816
    s_add_u32 s67, s65, 16384
    buffer_load_dwordx4 v2, s[40:43], s67 offen lds
    s_add_u32 m0, s70, 35840
    s_add_u32 s67, s65, 24576
    buffer_load_dwordx4 v3, s[40:43], s67 offen lds
    s_lshr_b32 s71, s70, 1
    s_add_u32 m0, s71, 49152
    s_add_u32 s67, s66, 1024
    buffer_load_dwordx4 v4, s[44:47], s67 offen lds
    s_add_u32 m0, s71, 50176
    s_add_u32 s67, s66, 25600
    buffer_load_dwordx4 v4, s[44:47], s67 offen lds
    s_add_u32 m0, s71, 57344
    s_add_u32 s67, s66, 2048
    buffer_load_dwordx4 v4, s[44:47], s67 offen lds
    s_add_u32 m0, s71, 58368
    s_add_u32 s67, s66, 26624
    buffer_load_dwordx4 v4, s[44:47], s67 offen lds
    s_waitcnt vmcnt(9)
    s_barrier
    s_add_u32 s64, s39, 7
    s_and_b32 s64, s64, 7
    s_lshl_b32 s65, s64, 7
    s_add_u32 s65, s65, s68
    s_mul_i32 s66, s64, 196608
    s_add_u32 s66, s66, s69
    s_add_u32 m0, s70, 65536
    s_add_u32 s67, s65, 0
    buffer_load_dwordx4 v2, s[40:43], s67 offen lds
    s_add_u32 m0, s70, 66560
    s_add_u32 s67, s65, 8192
    buffer_load_dwordx4 v3, s[40:43], s67 offen lds
    s_add_u32 m0, s70, 67584
    s_add_u32 s67, s65, 16384
    buffer_load_dwordx4 v2, s[40:43], s67 offen lds
    s_add_u32 m0, s70, 68608
    s_add_u32 s67, s65, 24576
    buffer_load_dwordx4 v3, s[40:43], s67 offen lds
    s_lshr_b32 s71, s70, 1
    s_add_u32 m0, s71, 81920
    s_add_u32 s67, s66, 1024
    buffer_load_dwordx4 v4, s[44:47], s67 offen lds
    s_add_u32 m0, s71, 82944
    s_add_u32 s67, s66, 25600
    buffer_load_dwordx4 v4, s[44:47], s67 offen lds
    s_add_u32 m0, s71, 90112
    s_add_u32 s67, s66, 2048
    buffer_load_dwordx4 v4, s[44:47], s67 offen lds
    s_add_u32 m0, s71, 91136
    s_add_u32 s67, s66, 26624
    buffer_load_dwordx4 v4, s[44:47], s67 offen lds
    s_waitcnt vmcnt(8)
    s_barrier
    s_add_u32 s64, s39, s3
    s_add_u32 s64, s64, 0
    s_and_b32 s64, s64, 7
    s_mul_i32 s64, s64, 196608
    s_lshl_b32 s65, s38, 7
    s_add_u32 s64, s64, s65
    s_lshl_b32 s66, s70, 1
    s_add_u32 m0, s66, 98304
    s_add_u32 s67, s64, 0
    buffer_load_dwordx4 v4, s[44:47], s67 offen lds
    s_add_u32 m0, s66, 99328
    s_add_u32 s67, s64, 24576
    buffer_load_dwordx4 v4, s[44:47], s67 offen lds
    s_add_u32 m0, s66, 100352
    s_add_u32 s67, s64, 49152
    buffer_load_dwordx4 v4, s[44:47], s67 offen lds
    s_add_u32 m0, s66, 101376
    s_add_u32 s67, s64, 73728
    buffer_load_dwordx4 v4, s[44:47], s67 offen lds
    s_add_u32 m0, s66, 102400
    s_add_u32 s67, s64, 98304
    buffer_load_dwordx4 v4, s[44:47], s67 offen lds
    s_add_u32 m0, s66, 103424
    s_add_u32 s67, s64, 122880
    buffer_load_dwordx4 v4, s[44:47], s67 offen lds
    s_add_u32 m0, s66, 104448
    s_add_u32 s67, s64, 147456
    buffer_load_dwordx4 v4, s[44:47], s67 offen lds
    s_add_u32 m0, s66, 105472
    s_add_u32 s67, s64, 172032
    buffer_load_dwordx4 v4, s[44:47], s67 offen lds
    s_waitcnt vmcnt(8)
    s_barrier
    s_add_u32 s64, s39, s3
    s_add_u32 s64, s64, 4
    s_and_b32 s64, s64, 7
    s_mul_i32 s64, s64, 196608
    s_lshl_b32 s65, s38, 7
    s_add_u32 s64, s64, s65
    s_lshl_b32 s66, s70, 1
    s_add_u32 m0, s66, 131072
    s_add_u32 s67, s64, 0
    buffer_load_dwordx4 v4, s[44:47], s67 offen lds
    s_add_u32 m0, s66, 132096
    s_add_u32 s67, s64, 24576
    buffer_load_dwordx4 v4, s[44:47], s67 offen lds
    s_add_u32 m0, s66, 133120
    s_add_u32 s67, s64, 49152
    buffer_load_dwordx4 v4, s[44:47], s67 offen lds
    s_add_u32 m0, s66, 134144
    s_add_u32 s67, s64, 73728
    buffer_load_dwordx4 v4, s[44:47], s67 offen lds
    s_add_u32 m0, s66, 135168
    s_add_u32 s67, s64, 98304
    buffer_load_dwordx4 v4, s[44:47], s67 offen lds
    s_add_u32 m0, s66, 136192
    s_add_u32 s67, s64, 122880
    buffer_load_dwordx4 v4, s[44:47], s67 offen lds
    s_add_u32 m0, s66, 137216
    s_add_u32 s67, s64, 147456
    buffer_load_dwordx4 v4, s[44:47], s67 offen lds
    s_add_u32 m0, s66, 138240
    s_add_u32 s67, s64, 172032
    buffer_load_dwordx4 v4, s[44:47], s67 offen lds
    v_lshlrev_b32 v13, 7, v0
    v_and_b32 v13, 0xfff, v13
    s_lshl_b32 s64, s37, 2
    s_add_u32 s64, s64, s3
    s_lshl_b32 s64, s64, 5
    s_lshl_b32 s65, s38, 2
    s_add_u32 s64, s64, s65
    s_lshl_b32 s64, s64, 10
    buffer_load_dword v250, v13, s[48:51], s64 offen sc1
    v_mov_b32 v14, s78
    v_mov_b32 v15, s79
    v_mov_b32 v13, 28672
    ds_write_b64 v13, v[14:15]
    s_waitcnt vmcnt(1)
    s_waitcnt lgkmcnt(0)
    s_barrier
    s_setprio 3
    v_mul_u32_u24 v7, 24, v0
    s_mul_i32 s64, s3, 1152
    v_add_u32 v7, s64, v7
    ds_read_b64 v[16:17], v7 offset:0
    ds_read_b64 v[18:19], v7 offset:8
    ds_read_b64 v[20:21], v7 offset:16
    ds_read_b64 v[22:23], v7 offset:4608
    ds_read_b64 v[24:25], v7 offset:4616
    ds_read_b64 v[26:27], v7 offset:4624
    ds_read_b64 v[28:29], v7 offset:9216
    ds_read_b64 v[30:31], v7 offset:9224
    ds_read_b64 v[32:33], v7 offset:9232
    ds_read_b64 v[34:35], v7 offset:13824
    ds_read_b64 v[36:37], v7 offset:13832
    ds_read_b64 v[38:39], v7 offset:13840
    v_lshlrev_b32 v3, 4, v0
    s_lshl_b32 s64, s38, 4
    s_add_u32 s64, s64, s37
    s_lshl_b32 s64, s64, 2
    s_add_u32 s64, s64, s3
    s_lshl_b32 s64, s64, 10
    s_add_u32 s64, s64, 6291456
    v_mov_b32 v51, s78
    s_waitcnt lgkmcnt(6)
    v_pk_add_f32 v[16:17], v[16:17], v[22:23]
    v_pk_add_f32 v[18:19], v[18:19], v[24:25]
    v_pk_add_f32 v[20:21], v[20:21], v[26:27]
    s_waitcnt lgkmcnt(0)
    v_pk_add_f32 v[28:29], v[28:29], v[34:35]
    v_pk_add_f32 v[30:31], v[30:31], v[36:37]
    v_pk_add_f32 v[32:33], v[32:33], v[38:39]
    v_pk_add_f32 v[16:17], v[16:17], v[28:29]
    v_pk_add_f32 v[18:19], v[18:19], v[30:31]
    v_pk_add_f32 v[20:21], v[20:21], v[32:33]
    v_cvt_pk_bf16_f32 v48, v16, v17
    v_cvt_pk_bf16_f32 v49, v18, v19
    v_cvt_pk_bf16_f32 v50, v20, v21
    s_mov_b64 s[66:67], exec
    s_mov_b32 exec_lo, -1
    s_mov_b32 exec_hi, 0x3fff
    buffer_store_dwordx4 v[48:51], v3, s[48:51], s64 offen sc1
    s_mov_b64 exec, s[66:67]
    s_mov_b32 s52, s8
    s_and_b32 s53, s9, 0xffff
    s_mov_b32 s54, 0x80000
    s_mov_b32 s55, 0x20000
    s_lshl_b32 s64, s3, 17
    s_lshl_b32 s65, s38, 7
    s_add_u32 s64, s64, s65
    s_lshl_b32 s65, s3, 14
    s_add_u32 m0, s65, 32768
    s_add_u32 s69, s64, 0
    buffer_load_dwordx4 v12, s[52:55], s69 offen lds
    s_add_u32 m0, s65, 33792
    s_add_u32 s69, s64, 8192
    buffer_load_dwordx4 v12, s[52:55], s69 offen lds
    s_add_u32 m0, s65, 34816
    s_add_u32 s69, s64, 16384
    buffer_load_dwordx4 v12, s[52:55], s69 offen lds
    s_add_u32 m0, s65, 35840
    s_add_u32 s69, s64, 24576
    buffer_load_dwordx4 v12, s[52:55], s69 offen lds
    s_add_u32 m0, s65, 36864
    s_add_u32 s69, s64, 32768
    buffer_load_dwordx4 v12, s[52:55], s69 offen lds
    s_add_u32 m0, s65, 37888
    s_add_u32 s69, s64, 40960
    buffer_load_dwordx4 v12, s[52:55], s69 offen lds
    s_add_u32 m0, s65, 38912
    s_add_u32 s69, s64, 49152
    buffer_load_dwordx4 v12, s[52:55], s69 offen lds
    s_add_u32 m0, s65, 39936
    s_add_u32 s69, s64, 57344
    buffer_load_dwordx4 v12, s[52:55], s69 offen lds
    s_add_u32 m0, s65, 40960
    s_add_u32 s69, s64, 65536
    buffer_load_dwordx4 v12, s[52:55], s69 offen lds
    s_add_u32 m0, s65, 41984
    s_add_u32 s69, s64, 73728
    buffer_load_dwordx4 v12, s[52:55], s69 offen lds
    s_add_u32 m0, s65, 43008
    s_add_u32 s69, s64, 81920
    buffer_load_dwordx4 v12, s[52:55], s69 offen lds
    s_add_u32 m0, s65, 44032
    s_add_u32 s69, s64, 90112
    buffer_load_dwordx4 v12, s[52:55], s69 offen lds
    s_add_u32 m0, s65, 45056
    s_add_u32 s69, s64, 98304
    buffer_load_dwordx4 v12, s[52:55], s69 offen lds
    s_add_u32 m0, s65, 46080
    s_add_u32 s69, s64, 106496
    buffer_load_dwordx4 v12, s[52:55], s69 offen lds
    s_add_u32 m0, s65, 47104
    s_add_u32 s69, s64, 114688
    buffer_load_dwordx4 v12, s[52:55], s69 offen lds
    s_add_u32 m0, s65, 48128
    s_add_u32 s69, s64, 122880
    buffer_load_dwordx4 v12, s[52:55], s69 offen lds
    s_waitcnt vmcnt(0)
    s_mov_b32 exec_lo, -1
    s_mov_b32 exec_hi, 0x3fff
    s_lshl_b32 s68, s38, 6
    s_add_u32 s68, s68, s3
    s_lshl_b32 s68, s68, 10
    s_add_u32 s68, s68, 6291456
    s_mov_b32 s72, 262144
    v_lshlrev_b32 v5, 12, v0
    v_add_u32 v5, 732, v5
    s_mov_b32 exec_lo, 0xffff
    s_mov_b32 exec_hi, 0
concat_heads__linear_attn_block__ssm_conv_s5__prompt_kernel_kv_light:
    buffer_load_dword v6, v5, s[48:51], s68 offen sc1
    s_waitcnt vmcnt(0)
    v_cmp_ne_u32 vcc, s78, v6
    s_sub_u32 s72, s72, 1
    s_cbranch_scc1 concat_heads__linear_attn_block__ssm_conv_s5__prompt_kernel_kv_lightok
    s_cbranch_vccnz concat_heads__linear_attn_block__ssm_conv_s5__prompt_kernel_kv_light
concat_heads__linear_attn_block__ssm_conv_s5__prompt_kernel_kv_lightok:
    s_mov_b32 exec_lo, -1
    s_mov_b32 exec_hi, 0x3fff
    s_mov_b32 s64, s68
    buffer_load_dwordx4 v[64:67], v3, s[48:51], s64 offen
    s_add_u32 s64, s64, 4096
    buffer_load_dwordx4 v[68:71], v3, s[48:51], s64 offen
    s_add_u32 s64, s64, 4096
    buffer_load_dwordx4 v[72:75], v3, s[48:51], s64 offen
    s_add_u32 s64, s64, 4096
    buffer_load_dwordx4 v[76:79], v3, s[48:51], s64 offen
    s_add_u32 s64, s64, 4096
    buffer_load_dwordx4 v[80:83], v3, s[48:51], s64 offen
    s_add_u32 s64, s64, 4096
    buffer_load_dwordx4 v[84:87], v3, s[48:51], s64 offen
    s_add_u32 s64, s64, 4096
    buffer_load_dwordx4 v[88:91], v3, s[48:51], s64 offen
    s_add_u32 s64, s64, 4096
    buffer_load_dwordx4 v[92:95], v3, s[48:51], s64 offen
    s_add_u32 s64, s64, 4096
    buffer_load_dwordx4 v[96:99], v3, s[48:51], s64 offen
    s_add_u32 s64, s64, 4096
    buffer_load_dwordx4 v[100:103], v3, s[48:51], s64 offen
    s_add_u32 s64, s64, 4096
    buffer_load_dwordx4 v[104:107], v3, s[48:51], s64 offen
    s_add_u32 s64, s64, 4096
    buffer_load_dwordx4 v[108:111], v3, s[48:51], s64 offen
    s_add_u32 s64, s64, 4096
    buffer_load_dwordx4 v[112:115], v3, s[48:51], s64 offen
    s_add_u32 s64, s64, 4096
    buffer_load_dwordx4 v[116:119], v3, s[48:51], s64 offen
    s_add_u32 s64, s64, 4096
    buffer_load_dwordx4 v[120:123], v3, s[48:51], s64 offen
    s_add_u32 s64, s64, 4096
    buffer_load_dwordx4 v[124:127], v3, s[48:51], s64 offen
    s_waitcnt vmcnt(0)
    v_xor_b32 v52, s78, v67
    v_xor_b32 v53, s78, v71
    v_or_b32 v52, v52, v53
    v_xor_b32 v53, s78, v75
    v_or_b32 v52, v52, v53
    v_xor_b32 v53, s78, v79
    v_or_b32 v52, v52, v53
    v_xor_b32 v53, s78, v83
    v_or_b32 v52, v52, v53
    v_xor_b32 v53, s78, v87
    v_or_b32 v52, v52, v53
    v_xor_b32 v53, s78, v91
    v_or_b32 v52, v52, v53
    v_xor_b32 v53, s78, v95
    v_or_b32 v52, v52, v53
    v_xor_b32 v53, s78, v99
    v_or_b32 v52, v52, v53
    v_xor_b32 v53, s78, v103
    v_or_b32 v52, v52, v53
    v_xor_b32 v53, s78, v107
    v_or_b32 v52, v52, v53
    v_xor_b32 v53, s78, v111
    v_or_b32 v52, v52, v53
    v_xor_b32 v53, s78, v115
    v_or_b32 v52, v52, v53
    v_xor_b32 v53, s78, v119
    v_or_b32 v52, v52, v53
    v_xor_b32 v53, s78, v123
    v_or_b32 v52, v52, v53
    v_xor_b32 v53, s78, v127
    v_or_b32 v52, v52, v53
    v_cmp_ne_u32 vcc, 0, v52
    s_cbranch_vccz concat_heads__linear_attn_block__ssm_conv_s5__prompt_kernel_kv_ok
concat_heads__linear_attn_block__ssm_conv_s5__prompt_kernel_kv_poll:
    s_mov_b32 s64, s68
    buffer_load_dwordx4 v[64:67], v3, s[48:51], s64 offen sc1
    s_add_u32 s64, s64, 4096
    buffer_load_dwordx4 v[68:71], v3, s[48:51], s64 offen sc1
    s_add_u32 s64, s64, 4096
    buffer_load_dwordx4 v[72:75], v3, s[48:51], s64 offen sc1
    s_add_u32 s64, s64, 4096
    buffer_load_dwordx4 v[76:79], v3, s[48:51], s64 offen sc1
    s_add_u32 s64, s64, 4096
    buffer_load_dwordx4 v[80:83], v3, s[48:51], s64 offen sc1
    s_add_u32 s64, s64, 4096
    buffer_load_dwordx4 v[84:87], v3, s[48:51], s64 offen sc1
    s_add_u32 s64, s64, 4096
    buffer_load_dwordx4 v[88:91], v3, s[48:51], s64 offen sc1
    s_add_u32 s64, s64, 4096
    buffer_load_dwordx4 v[92:95], v3, s[48:51], s64 offen sc1
    s_add_u32 s64, s64, 4096
    buffer_load_dwordx4 v[96:99], v3, s[48:51], s64 offen sc1
    s_add_u32 s64, s64, 4096
    buffer_load_dwordx4 v[100:103], v3, s[48:51], s64 offen sc1
    s_add_u32 s64, s64, 4096
    buffer_load_dwordx4 v[104:107], v3, s[48:51], s64 offen sc1
    s_add_u32 s64, s64, 4096
    buffer_load_dwordx4 v[108:111], v3, s[48:51], s64 offen sc1
    s_add_u32 s64, s64, 4096
    buffer_load_dwordx4 v[112:115], v3, s[48:51], s64 offen sc1
    s_add_u32 s64, s64, 4096
    buffer_load_dwordx4 v[116:119], v3, s[48:51], s64 offen sc1
    s_add_u32 s64, s64, 4096
    buffer_load_dwordx4 v[120:123], v3, s[48:51], s64 offen sc1
    s_add_u32 s64, s64, 4096
    buffer_load_dwordx4 v[124:127], v3, s[48:51], s64 offen sc1
    s_waitcnt vmcnt(0)
    v_xor_b32 v52, s78, v67
    v_xor_b32 v53, s78, v71
    v_or_b32 v52, v52, v53
    v_xor_b32 v53, s78, v75
    v_or_b32 v52, v52, v53
    v_xor_b32 v53, s78, v79
    v_or_b32 v52, v52, v53
    v_xor_b32 v53, s78, v83
    v_or_b32 v52, v52, v53
    v_xor_b32 v53, s78, v87
    v_or_b32 v52, v52, v53
    v_xor_b32 v53, s78, v91
    v_or_b32 v52, v52, v53
    v_xor_b32 v53, s78, v95
    v_or_b32 v52, v52, v53
    v_xor_b32 v53, s78, v99
    v_or_b32 v52, v52, v53
    v_xor_b32 v53, s78, v103
    v_or_b32 v52, v52, v53
    v_xor_b32 v53, s78, v107
    v_or_b32 v52, v52, v53
    v_xor_b32 v53, s78, v111
    v_or_b32 v52, v52, v53
    v_xor_b32 v53, s78, v115
    v_or_b32 v52, v52, v53
    v_xor_b32 v53, s78, v119
    v_or_b32 v52, v52, v53
    v_xor_b32 v53, s78, v123
    v_or_b32 v52, v52, v53
    v_xor_b32 v53, s78, v127
    v_or_b32 v52, v52, v53
    v_cmp_ne_u32 vcc, 0, v52
    s_sub_u32 s72, s72, 1
    s_cbranch_scc1 concat_heads__linear_attn_block__ssm_conv_s5__prompt_kernel_kv_ok
    s_cbranch_vccnz concat_heads__linear_attn_block__ssm_conv_s5__prompt_kernel_kv_poll
concat_heads__linear_attn_block__ssm_conv_s5__prompt_kernel_kv_ok:
    s_mov_b64 exec, s[66:67]
    v_mov_b32 v16, 0
    v_mov_b32 v17, 0
    v_mov_b32 v18, 0
    v_mov_b32 v19, 0
    v_mov_b32 v20, 0
    v_mov_b32 v21, 0
    v_mov_b32 v24, 0x00003f80
    v_mov_b32 v25, 0x3f800000
    v_dot2c_f32_bf16 v16, v64, v24
    v_dot2c_f32_bf16 v17, v64, v25
    v_dot2c_f32_bf16 v18, v65, v24
    v_dot2c_f32_bf16 v19, v65, v25
    v_dot2c_f32_bf16 v20, v66, v24
    v_dot2c_f32_bf16 v21, v66, v25
    v_dot2c_f32_bf16 v16, v68, v24
    v_dot2c_f32_bf16 v17, v68, v25
    v_dot2c_f32_bf16 v18, v69, v24
    v_dot2c_f32_bf16 v19, v69, v25
    v_dot2c_f32_bf16 v20, v70, v24
    v_dot2c_f32_bf16 v21, v70, v25
    v_dot2c_f32_bf16 v16, v72, v24
    v_dot2c_f32_bf16 v17, v72, v25
    v_dot2c_f32_bf16 v18, v73, v24
    v_dot2c_f32_bf16 v19, v73, v25
    v_dot2c_f32_bf16 v20, v74, v24
    v_dot2c_f32_bf16 v21, v74, v25
    v_dot2c_f32_bf16 v16, v76, v24
    v_dot2c_f32_bf16 v17, v76, v25
    v_dot2c_f32_bf16 v18, v77, v24
    v_dot2c_f32_bf16 v19, v77, v25
    v_dot2c_f32_bf16 v20, v78, v24
    v_dot2c_f32_bf16 v21, v78, v25
    v_dot2c_f32_bf16 v16, v80, v24
    v_dot2c_f32_bf16 v17, v80, v25
    v_dot2c_f32_bf16 v18, v81, v24
    v_dot2c_f32_bf16 v19, v81, v25
    v_dot2c_f32_bf16 v20, v82, v24
    v_dot2c_f32_bf16 v21, v82, v25
    v_dot2c_f32_bf16 v16, v84, v24
    v_dot2c_f32_bf16 v17, v84, v25
    v_dot2c_f32_bf16 v18, v85, v24
    v_dot2c_f32_bf16 v19, v85, v25
    v_dot2c_f32_bf16 v20, v86, v24
    v_dot2c_f32_bf16 v21, v86, v25
    v_dot2c_f32_bf16 v16, v88, v24
    v_dot2c_f32_bf16 v17, v88, v25
    v_dot2c_f32_bf16 v18, v89, v24
    v_dot2c_f32_bf16 v19, v89, v25
    v_dot2c_f32_bf16 v20, v90, v24
    v_dot2c_f32_bf16 v21, v90, v25
    v_dot2c_f32_bf16 v16, v92, v24
    v_dot2c_f32_bf16 v17, v92, v25
    v_dot2c_f32_bf16 v18, v93, v24
    v_dot2c_f32_bf16 v19, v93, v25
    v_dot2c_f32_bf16 v20, v94, v24
    v_dot2c_f32_bf16 v21, v94, v25
    v_dot2c_f32_bf16 v16, v96, v24
    v_dot2c_f32_bf16 v17, v96, v25
    v_dot2c_f32_bf16 v18, v97, v24
    v_dot2c_f32_bf16 v19, v97, v25
    v_dot2c_f32_bf16 v20, v98, v24
    v_dot2c_f32_bf16 v21, v98, v25
    v_dot2c_f32_bf16 v16, v100, v24
    v_dot2c_f32_bf16 v17, v100, v25
    v_dot2c_f32_bf16 v18, v101, v24
    v_dot2c_f32_bf16 v19, v101, v25
    v_dot2c_f32_bf16 v20, v102, v24
    v_dot2c_f32_bf16 v21, v102, v25
    v_dot2c_f32_bf16 v16, v104, v24
    v_dot2c_f32_bf16 v17, v104, v25
    v_dot2c_f32_bf16 v18, v105, v24
    v_dot2c_f32_bf16 v19, v105, v25
    v_dot2c_f32_bf16 v20, v106, v24
    v_dot2c_f32_bf16 v21, v106, v25
    v_dot2c_f32_bf16 v16, v108, v24
    v_dot2c_f32_bf16 v17, v108, v25
    v_dot2c_f32_bf16 v18, v109, v24
    v_dot2c_f32_bf16 v19, v109, v25
    v_dot2c_f32_bf16 v20, v110, v24
    v_dot2c_f32_bf16 v21, v110, v25
    v_dot2c_f32_bf16 v16, v112, v24
    v_dot2c_f32_bf16 v17, v112, v25
    v_dot2c_f32_bf16 v18, v113, v24
    v_dot2c_f32_bf16 v19, v113, v25
    v_dot2c_f32_bf16 v20, v114, v24
    v_dot2c_f32_bf16 v21, v114, v25
    v_dot2c_f32_bf16 v16, v116, v24
    v_dot2c_f32_bf16 v17, v116, v25
    v_dot2c_f32_bf16 v18, v117, v24
    v_dot2c_f32_bf16 v19, v117, v25
    v_dot2c_f32_bf16 v20, v118, v24
    v_dot2c_f32_bf16 v21, v118, v25
    v_dot2c_f32_bf16 v16, v120, v24
    v_dot2c_f32_bf16 v17, v120, v25
    v_dot2c_f32_bf16 v18, v121, v24
    v_dot2c_f32_bf16 v19, v121, v25
    v_dot2c_f32_bf16 v20, v122, v24
    v_dot2c_f32_bf16 v21, v122, v25
    v_dot2c_f32_bf16 v16, v124, v24
    v_dot2c_f32_bf16 v17, v124, v25
    v_dot2c_f32_bf16 v18, v125, v24
    v_dot2c_f32_bf16 v19, v125, v25
    v_dot2c_f32_bf16 v20, v126, v24
    v_dot2c_f32_bf16 v21, v126, v25
    s_nop 2
    v_cvt_pk_bf16_f32 v48, v16, v17
    v_cvt_pk_bf16_f32 v49, v18, v19
    v_cvt_pk_bf16_f32 v50, v20, v21
    v_mul_u32_u24 v4, 12, v0
    s_lshl_b32 s66, s3, 10
    s_add_u32 s66, s66, 20480
    v_add_u32 v4, s66, v4
    s_mov_b64 s[66:67], exec
    s_mov_b32 exec_lo, -1
    s_mov_b32 exec_hi, 0x3fff
    ds_write_b32 v4, v48 offset:0
    ds_write_b32 v4, v49 offset:4
    ds_write_b32 v4, v50 offset:8
    s_mov_b64 exec, s[66:67]
    s_waitcnt lgkmcnt(0)
    s_barrier
    s_setprio 0
    v_mov_b32 v128, 0
    v_mov_b32 v129, 0
    v_mov_b32 v130, 0
    v_mov_b32 v131, 0
    v_mov_b32 v132, 0
    v_mov_b32 v133, 0
    v_mov_b32 v134, 0
    v_mov_b32 v135, 0
    v_mov_b32 v136, 0
    v_mov_b32 v137, 0
    v_mov_b32 v138, 0
    v_mov_b32 v139, 0
    v_mov_b32 v140, 0
    v_mov_b32 v141, 0
    v_mov_b32 v142, 0
    v_mov_b32 v143, 0
    v_mov_b32 v144, 0
    v_mov_b32 v145, 0
    v_mov_b32 v146, 0
    v_mov_b32 v147, 0
    v_mov_b32 v148, 0
    v_mov_b32 v149, 0
    v_mov_b32 v150, 0
    v_mov_b32 v151, 0
    v_mov_b32 v152, 0
    v_mov_b32 v153, 0
    v_mov_b32 v154, 0
    v_mov_b32 v155, 0
    v_mov_b32 v156, 0
    v_mov_b32 v157, 0
    v_mov_b32 v158, 0
    v_mov_b32 v159, 0
    s_waitcnt vmcnt(0)
    s_barrier
concat_heads__linear_attn_block__ssm_conv_s5__prompt_kernel_p2A:
    s_lshr_b32 s64, s34, 2
    s_and_b32 s65, s34, 3
    v_lshlrev_b32 v2, 4, v0
    s_lshl_b32 s66, s37, 2
    s_add_u32 s66, s66, s65
    s_mul_i32 s66, s66, 32768
    s_mul_i32 s67, s64, 16384
    s_add_u32 s66, s66, s67
    s_add_u32 s66, s66, 0
    v_and_b32 v5, 31, v0
    v_lshrrev_b32 v6, 5, v0
    s_lshl_b32 s68, s37, 7
    s_lshl_b32 s69, s65, 5
    s_add_u32 s68, s68, s69
    s_lshl_b32 s69, s38, 6
    s_lshl_b32 s70, s64, 5
    s_add_u32 s69, s69, s70
    v_lshlrev_b32 v12, 2, v6
    v_bfe_u32 v13, v0, 2, 2
    v_add_u32 v12, v12, v13
    v_lshlrev_b32 v12, 7, v12
    v_bfe_u32 v13, v0, 3, 1
    v_lshlrev_b32 v13, 6, v13
    v_add_u32 v12, v12, v13
    v_bfe_u32 v13, v0, 4, 1
    v_lshlrev_b32 v13, 5, v13
    v_add_u32 v12, v12, v13
    v_and_b32 v13, 3, v0
    v_lshlrev_b32 v13, 3, v13
    v_add_u32 v12, v12, v13
    s_lshl_b32 s70, s64, 15
    s_add_u32 s70, s70, 32768
    v_add_u32 v3, s70, v12
    v_xor_b32 v4, 64, v3
    ds_read_b64_tr_b16 v[48:49], v3 offset:0
    ds_read_b64_tr_b16 v[50:51], v3 offset:1024
    ds_read_b64_tr_b16 v[52:53], v4 offset:0
    ds_read_b64_tr_b16 v[54:55], v4 offset:1024
    ds_read_b64_tr_b16 v[56:57], v3 offset:2048
    ds_read_b64_tr_b16 v[58:59], v3 offset:3072
    ds_read_b64_tr_b16 v[60:61], v4 offset:2048
    ds_read_b64_tr_b16 v[62:63], v4 offset:3072
    ds_read_b64_tr_b16 v[64:65], v3 offset:4096
    ds_read_b64_tr_b16 v[66:67], v3 offset:5120
    ds_read_b64_tr_b16 v[68:69], v4 offset:4096
    ds_read_b64_tr_b16 v[70:71], v4 offset:5120
    s_mov_b32 s76, s64
    s_mov_b32 s77, s66
    s_add_u32 s64, s37, 0
    s_lshl_b32 s64, s64, 10
    s_add_u32 s64, s64, 7602176
    s_lshr_b32 s65, s34, 2
    s_lshl_b32 s65, s65, 9
    s_add_u32 s64, s64, s65
    s_mov_b32 s72, 262144
    s_lshl_b32 s65, s3, 3
    v_lshlrev_b32 v10, 7, v0
    v_add_u32 v10, s65, v10
    s_mov_b64 s[74:75], exec
    s_mov_b64 exec, 0xf
concat_heads__linear_attn_block__ssm_conv_s5__prompt_kernel_fpoll_A:
    buffer_load_dwordx2 v[8:9], v10, s[48:51], s64 offen sc1
    s_waitcnt vmcnt(0)
    v_xor_b32 v8, s78, v8
    v_xor_b32 v9, s79, v9
    v_or_b32 v8, v8, v9
    v_cmp_ne_u32 vcc, 0, v8
    s_sub_u32 s72, s72, 1
    s_cbranch_scc1 concat_heads__linear_attn_block__ssm_conv_s5__prompt_kernel_fpolld_A
    s_cbranch_vccz concat_heads__linear_attn_block__ssm_conv_s5__prompt_kernel_fpolld_A
    s_branch concat_heads__linear_attn_block__ssm_conv_s5__prompt_kernel_fpoll_A
concat_heads__linear_attn_block__ssm_conv_s5__prompt_kernel_fpolld_A:
    s_mov_b64 exec, s[74:75]
    s_mov_b32 s64, s76
    s_mov_b32 s66, s77
    buffer_load_dwordx4 v[80:83], v2, s[48:51], s66 offen offset:0
    buffer_load_dwordx4 v[84:87], v2, s[48:51], s66 offen offset:1024
    buffer_load_dwordx4 v[88:91], v2, s[48:51], s66 offen offset:2048
    buffer_load_dwordx4 v[92:95], v2, s[48:51], s66 offen offset:3072
    s_add_u32 s66, s66, 4096
    buffer_load_dwordx4 v[96:99], v2, s[48:51], s66 offen offset:0
    buffer_load_dwordx4 v[100:103], v2, s[48:51], s66 offen offset:1024
    buffer_load_dwordx4 v[104:107], v2, s[48:51], s66 offen offset:2048
    buffer_load_dwordx4 v[108:111], v2, s[48:51], s66 offen offset:3072
    s_add_u32 s66, s66, 4096
    ds_read_b64_tr_b16 v[72:73], v3 offset:6144
    ds_read_b64_tr_b16 v[74:75], v3 offset:7168
    ds_read_b64_tr_b16 v[76:77], v4 offset:6144
    ds_read_b64_tr_b16 v[78:79], v4 offset:7168
    s_waitcnt vmcnt(7)
    s_waitcnt lgkmcnt(12)
    v_mfma_f32_32x32x16_bf16 v[128:143], v[80:83], v[48:51], v[128:143]
    v_mfma_f32_32x32x16_bf16 v[144:159], v[80:83], v[52:55], v[144:159]
    buffer_load_dwordx4 v[80:83], v2, s[48:51], s66 offen offset:0
    ds_read_b64_tr_b16 v[48:49], v3 offset:8192
    ds_read_b64_tr_b16 v[50:51], v3 offset:9216
    ds_read_b64_tr_b16 v[52:53], v4 offset:8192
    ds_read_b64_tr_b16 v[54:55], v4 offset:9216
    s_waitcnt vmcnt(7)
    s_waitcnt lgkmcnt(12)
    v_mfma_f32_32x32x16_bf16 v[128:143], v[84:87], v[56:59], v[128:143]
    v_mfma_f32_32x32x16_bf16 v[144:159], v[84:87], v[60:63], v[144:159]
    buffer_load_dwordx4 v[84:87], v2, s[48:51], s66 offen offset:1024
    ds_read_b64_tr_b16 v[56:57], v3 offset:10240
    ds_read_b64_tr_b16 v[58:59], v3 offset:11264
    ds_read_b64_tr_b16 v[60:61], v4 offset:10240
    ds_read_b64_tr_b16 v[62:63], v4 offset:11264
    s_waitcnt vmcnt(7)
    s_waitcnt lgkmcnt(12)
    v_mfma_f32_32x32x16_bf16 v[128:143], v[88:91], v[64:67], v[128:143]
    v_mfma_f32_32x32x16_bf16 v[144:159], v[88:91], v[68:71], v[144:159]
    buffer_load_dwordx4 v[88:91], v2, s[48:51], s66 offen offset:2048
    ds_read_b64_tr_b16 v[64:65], v3 offset:12288
    ds_read_b64_tr_b16 v[66:67], v3 offset:13312
    ds_read_b64_tr_b16 v[68:69], v4 offset:12288
    ds_read_b64_tr_b16 v[70:71], v4 offset:13312
    s_waitcnt vmcnt(7)
    s_waitcnt lgkmcnt(12)
    v_mfma_f32_32x32x16_bf16 v[128:143], v[92:95], v[72:75], v[128:143]
    v_mfma_f32_32x32x16_bf16 v[144:159], v[92:95], v[76:79], v[144:159]
    buffer_load_dwordx4 v[92:95], v2, s[48:51], s66 offen offset:3072
    s_add_u32 s66, s66, 4096
    ds_read_b64_tr_b16 v[72:73], v3 offset:14336
    ds_read_b64_tr_b16 v[74:75], v3 offset:15360
    ds_read_b64_tr_b16 v[76:77], v4 offset:14336
    ds_read_b64_tr_b16 v[78:79], v4 offset:15360
    s_waitcnt vmcnt(7)
    s_waitcnt lgkmcnt(12)
    v_mfma_f32_32x32x16_bf16 v[128:143], v[96:99], v[48:51], v[128:143]
    v_mfma_f32_32x32x16_bf16 v[144:159], v[96:99], v[52:55], v[144:159]
    buffer_load_dwordx4 v[96:99], v2, s[48:51], s66 offen offset:0
    ds_read_b64_tr_b16 v[48:49], v3 offset:16384
    ds_read_b64_tr_b16 v[50:51], v3 offset:17408
    ds_read_b64_tr_b16 v[52:53], v4 offset:16384
    ds_read_b64_tr_b16 v[54:55], v4 offset:17408
    s_waitcnt vmcnt(7)
    s_waitcnt lgkmcnt(12)
    v_mfma_f32_32x32x16_bf16 v[128:143], v[100:103], v[56:59], v[128:143]
    v_mfma_f32_32x32x16_bf16 v[144:159], v[100:103], v[60:63], v[144:159]
    buffer_load_dwordx4 v[100:103], v2, s[48:51], s66 offen offset:1024
    ds_read_b64_tr_b16 v[56:57], v3 offset:18432
    ds_read_b64_tr_b16 v[58:59], v3 offset:19456
    ds_read_b64_tr_b16 v[60:61], v4 offset:18432
    ds_read_b64_tr_b16 v[62:63], v4 offset:19456
    s_waitcnt vmcnt(7)
    s_waitcnt lgkmcnt(12)
    v_mfma_f32_32x32x16_bf16 v[128:143], v[104:107], v[64:67], v[128:143]
    v_mfma_f32_32x32x16_bf16 v[144:159], v[104:107], v[68:71], v[144:159]
    buffer_load_dwordx4 v[104:107], v2, s[48:51], s66 offen offset:2048
    ds_read_b64_tr_b16 v[64:65], v3 offset:20480
    ds_read_b64_tr_b16 v[66:67], v3 offset:21504
    ds_read_b64_tr_b16 v[68:69], v4 offset:20480
    ds_read_b64_tr_b16 v[70:71], v4 offset:21504
    s_waitcnt vmcnt(7)
    s_waitcnt lgkmcnt(12)
    v_mfma_f32_32x32x16_bf16 v[128:143], v[108:111], v[72:75], v[128:143]
    v_mfma_f32_32x32x16_bf16 v[144:159], v[108:111], v[76:79], v[144:159]
    buffer_load_dwordx4 v[108:111], v2, s[48:51], s66 offen offset:3072
    s_add_u32 s66, s66, 4096
    ds_read_b64_tr_b16 v[72:73], v3 offset:22528
    ds_read_b64_tr_b16 v[74:75], v3 offset:23552
    ds_read_b64_tr_b16 v[76:77], v4 offset:22528
    ds_read_b64_tr_b16 v[78:79], v4 offset:23552
    s_waitcnt vmcnt(7)
    s_waitcnt lgkmcnt(12)
    v_mfma_f32_32x32x16_bf16 v[128:143], v[80:83], v[48:51], v[128:143]
    v_mfma_f32_32x32x16_bf16 v[144:159], v[80:83], v[52:55], v[144:159]
    ds_read_b64_tr_b16 v[48:49], v3 offset:24576
    ds_read_b64_tr_b16 v[50:51], v3 offset:25600
    ds_read_b64_tr_b16 v[52:53], v4 offset:24576
    ds_read_b64_tr_b16 v[54:55], v4 offset:25600
    s_waitcnt vmcnt(6)
    s_waitcnt lgkmcnt(12)
    v_mfma_f32_32x32x16_bf16 v[128:143], v[84:87], v[56:59], v[128:143]
    v_mfma_f32_32x32x16_bf16 v[144:159], v[84:87], v[60:63], v[144:159]
    ds_read_b64_tr_b16 v[56:57], v3 offset:26624
    ds_read_b64_tr_b16 v[58:59], v3 offset:27648
    ds_read_b64_tr_b16 v[60:61], v4 offset:26624
    ds_read_b64_tr_b16 v[62:63], v4 offset:27648
    s_waitcnt vmcnt(5)
    s_waitcnt lgkmcnt(12)
    v_mfma_f32_32x32x16_bf16 v[128:143], v[88:91], v[64:67], v[128:143]
    v_mfma_f32_32x32x16_bf16 v[144:159], v[88:91], v[68:71], v[144:159]
    ds_read_b64_tr_b16 v[64:65], v3 offset:28672
    ds_read_b64_tr_b16 v[66:67], v3 offset:29696
    ds_read_b64_tr_b16 v[68:69], v4 offset:28672
    ds_read_b64_tr_b16 v[70:71], v4 offset:29696
    s_waitcnt vmcnt(4)
    s_waitcnt lgkmcnt(12)
    v_mfma_f32_32x32x16_bf16 v[128:143], v[92:95], v[72:75], v[128:143]
    v_mfma_f32_32x32x16_bf16 v[144:159], v[92:95], v[76:79], v[144:159]
    ds_read_b64_tr_b16 v[72:73], v3 offset:30720
    ds_read_b64_tr_b16 v[74:75], v3 offset:31744
    ds_read_b64_tr_b16 v[76:77], v4 offset:30720
    ds_read_b64_tr_b16 v[78:79], v4 offset:31744
    s_waitcnt vmcnt(3)
    s_waitcnt lgkmcnt(12)
    v_mfma_f32_32x32x16_bf16 v[128:143], v[96:99], v[48:51], v[128:143]
    v_mfma_f32_32x32x16_bf16 v[144:159], v[96:99], v[52:55], v[144:159]
    s_waitcnt vmcnt(2)
    s_waitcnt lgkmcnt(8)
    v_mfma_f32_32x32x16_bf16 v[128:143], v[100:103], v[56:59], v[128:143]
    v_mfma_f32_32x32x16_bf16 v[144:159], v[100:103], v[60:63], v[144:159]
    s_waitcnt vmcnt(1)
    s_waitcnt lgkmcnt(4)
    v_mfma_f32_32x32x16_bf16 v[128:143], v[104:107], v[64:67], v[128:143]
    v_mfma_f32_32x32x16_bf16 v[144:159], v[104:107], v[68:71], v[144:159]
    s_waitcnt vmcnt(0)
    s_waitcnt lgkmcnt(0)
    v_mfma_f32_32x32x16_bf16 v[128:143], v[108:111], v[72:75], v[128:143]
    v_mfma_f32_32x32x16_bf16 v[144:159], v[108:111], v[76:79], v[144:159]
    s_lshl_b32 s70, s34, 12
    s_add_u32 s70, s70, 131072
    v_add_u32 v9, s70, v2
    s_xor_b32 s71, s34, 4
    s_lshl_b32 s71, s71, 12
    s_add_u32 s71, s71, 131072
    v_add_u32 v10, s71, v2
    s_lshl_b32 s68, s68, 12
    s_lshl_b32 s69, s69, 2
    s_add_u32 s68, s68, s69
    v_lshlrev_b32 v11, 14, v6
    v_lshlrev_b32 v12, 2, v5
    v_add_u32 v11, v11, v12
    s_mov_b32 s52, s28
    s_and_b32 s53, s29, 0xffff
    s_mov_b32 s54, 0x800000
    s_mov_b32 s55, 0x20000
    s_cmp_eq_u32 s64, 1
    s_cbranch_scc1 concat_heads__linear_attn_block__ssm_conv_s5__prompt_kernel_kh1_A
    ds_write_b128 v9, v[144:147] offset:0
    ds_write_b128 v9, v[148:151] offset:1024
    ds_write_b128 v9, v[152:155] offset:2048
    ds_write_b128 v9, v[156:159] offset:3072
    s_mov_b32 s71, 0
    s_branch concat_heads__linear_attn_block__ssm_conv_s5__prompt_kernel_join_A
concat_heads__linear_attn_block__ssm_conv_s5__prompt_kernel_kh1_A:
    ds_write_b128 v9, v[128:131] offset:0
    ds_write_b128 v9, v[132:135] offset:1024
    ds_write_b128 v9, v[136:139] offset:2048
    ds_write_b128 v9, v[140:143] offset:3072
    s_nop 1
    v_mov_b32 v128, v144
    v_mov_b32 v129, v145
    v_mov_b32 v130, v146
    v_mov_b32 v131, v147
    v_mov_b32 v132, v148
    v_mov_b32 v133, v149
    v_mov_b32 v134, v150
    v_mov_b32 v135, v151
    v_mov_b32 v136, v152
    v_mov_b32 v137, v153
    v_mov_b32 v138, v154
    v_mov_b32 v139, v155
    v_mov_b32 v140, v156
    v_mov_b32 v141, v157
    v_mov_b32 v142, v158
    v_mov_b32 v143, v159
concat_heads__linear_attn_block__ssm_conv_s5__prompt_kernel_join_A:
    s_waitcnt lgkmcnt(0)
    s_barrier
    ds_read_b128 v[48:51], v10 offset:0
    ds_read_b128 v[52:55], v10 offset:1024
    ds_read_b128 v[56:59], v10 offset:2048
    ds_read_b128 v[60:63], v10 offset:3072
    s_waitcnt lgkmcnt(3)
    v_pk_add_f32 v[128:129], v[128:129], v[48:49]
    v_pk_add_f32 v[130:131], v[130:131], v[50:51]
    s_add_u32 s69, s68, 0
    buffer_store_dword v128, v11, s[52:55], s69 offen nt
    s_add_u32 s69, s68, 4096
    buffer_store_dword v129, v11, s[52:55], s69 offen nt
    s_add_u32 s69, s68, 8192
    buffer_store_dword v130, v11, s[52:55], s69 offen nt
    s_add_u32 s69, s68, 12288
    buffer_store_dword v131, v11, s[52:55], s69 offen nt
    s_waitcnt lgkmcnt(2)
    v_pk_add_f32 v[132:133], v[132:133], v[52:53]
    v_pk_add_f32 v[134:135], v[134:135], v[54:55]
    s_add_u32 s69, s68, 32768
    buffer_store_dword v132, v11, s[52:55], s69 offen nt
    s_add_u32 s69, s68, 36864
    buffer_store_dword v133, v11, s[52:55], s69 offen nt
    s_add_u32 s69, s68, 40960
    buffer_store_dword v134, v11, s[52:55], s69 offen nt
    s_add_u32 s69, s68, 45056
    buffer_store_dword v135, v11, s[52:55], s69 offen nt
    s_waitcnt lgkmcnt(1)
    v_pk_add_f32 v[136:137], v[136:137], v[56:57]
    v_pk_add_f32 v[138:139], v[138:139], v[58:59]
    s_add_u32 s69, s68, 65536
    buffer_store_dword v136, v11, s[52:55], s69 offen nt
    s_add_u32 s69, s68, 69632
    buffer_store_dword v137, v11, s[52:55], s69 offen nt
    s_add_u32 s69, s68, 73728
    buffer_store_dword v138, v11, s[52:55], s69 offen nt
    s_add_u32 s69, s68, 77824
    buffer_store_dword v139, v11, s[52:55], s69 offen nt
    s_waitcnt lgkmcnt(0)
    v_pk_add_f32 v[140:141], v[140:141], v[60:61]
    v_pk_add_f32 v[142:143], v[142:143], v[62:63]
    s_add_u32 s69, s68, 98304
    buffer_store_dword v140, v11, s[52:55], s69 offen nt
    s_add_u32 s69, s68, 102400
    buffer_store_dword v141, v11, s[52:55], s69 offen nt
    s_add_u32 s69, s68, 106496
    buffer_store_dword v142, v11, s[52:55], s69 offen nt
    s_add_u32 s69, s68, 110592
    buffer_store_dword v143, v11, s[52:55], s69 offen nt
    s_endpgm
concat_heads__linear_attn_block__ssm_conv_s5__prompt_kernel_bu_load:
    s_waitcnt lgkmcnt(0)
    s_mov_b32 s48, s32
    s_and_b32 s49, s33, 0xffff
    s_mov_b32 s50, 0x10000000
    s_mov_b32 s51, 0x20000
    s_waitcnt vmcnt(8)
    s_barrier
    s_add_u32 s64, s39, 2
    s_and_b32 s64, s64, 7
    s_lshl_b32 s65, s64, 7
    s_add_u32 s65, s65, s68
    s_lshl_b32 s66, s64, 7
    s_add_u32 s66, s66, s69
    s_add_u32 m0, s70, 65536
    s_add_u32 s67, s65, 0
    buffer_load_dwordx4 v4, s[40:43], s67 offen lds
    s_add_u32 m0, s70, 66560
    s_add_u32 s67, s65, 65536
    buffer_load_dwordx4 v11, s[40:43], s67 offen lds
    s_add_u32 m0, s70, 67584
    s_add_u32 s67, s65, 2048
    buffer_load_dwordx4 v4, s[40:43], s67 offen lds
    s_add_u32 m0, s70, 68608
    s_add_u32 s67, s65, 67584
    buffer_load_dwordx4 v11, s[40:43], s67 offen lds
    s_add_u32 m0, s70, 81920
    s_add_u32 s67, s66, 0
    buffer_load_dwordx4 v2, s[44:47], s67 offen lds
    s_add_u32 m0, s70, 82944
    s_add_u32 s67, s66, 8192
    buffer_load_dwordx4 v3, s[44:47], s67 offen lds
    s_add_u32 m0, s70, 83968
    s_add_u32 s67, s66, 16384
    buffer_load_dwordx4 v2, s[44:47], s67 offen lds
    s_add_u32 m0, s70, 84992
    s_add_u32 s67, s66, 24576
    buffer_load_dwordx4 v3, s[44:47], s67 offen lds
    s_waitcnt vmcnt(8)
    s_barrier
    s_add_u32 s64, s39, 3
    s_and_b32 s64, s64, 7
    s_lshl_b32 s65, s64, 7
    s_add_u32 s65, s65, s68
    s_lshl_b32 s66, s64, 7
    s_add_u32 s66, s66, s69
    s_add_u32 m0, s70, 98304
    s_add_u32 s67, s65, 0
    buffer_load_dwordx4 v4, s[40:43], s67 offen lds
    s_add_u32 m0, s70, 99328
    s_add_u32 s67, s65, 65536
    buffer_load_dwordx4 v11, s[40:43], s67 offen lds
    s_add_u32 m0, s70, 100352
    s_add_u32 s67, s65, 2048
    buffer_load_dwordx4 v4, s[40:43], s67 offen lds
    s_add_u32 m0, s70, 101376
    s_add_u32 s67, s65, 67584
    buffer_load_dwordx4 v11, s[40:43], s67 offen lds
    s_add_u32 m0, s70, 114688
    s_add_u32 s67, s66, 0
    buffer_load_dwordx4 v2, s[44:47], s67 offen lds
    s_add_u32 m0, s70, 115712
    s_add_u32 s67, s66, 8192
    buffer_load_dwordx4 v3, s[44:47], s67 offen lds
    s_add_u32 m0, s70, 116736
    s_add_u32 s67, s66, 16384
    buffer_load_dwordx4 v2, s[44:47], s67 offen lds
    s_add_u32 m0, s70, 117760
    s_add_u32 s67, s66, 24576
    buffer_load_dwordx4 v3, s[44:47], s67 offen lds
    s_waitcnt vmcnt(8)
    s_barrier
    s_add_u32 s64, s39, 4
    s_and_b32 s64, s64, 7
    s_lshl_b32 s65, s64, 7
    s_add_u32 s65, s65, s68
    s_lshl_b32 s66, s64, 7
    s_add_u32 s66, s66, s69
    s_add_u32 m0, s70, 131072
    s_add_u32 s67, s65, 0
    buffer_load_dwordx4 v4, s[40:43], s67 offen lds
    s_add_u32 m0, s70, 132096
    s_add_u32 s67, s65, 65536
    buffer_load_dwordx4 v11, s[40:43], s67 offen lds
    s_add_u32 m0, s70, 133120
    s_add_u32 s67, s65, 2048
    buffer_load_dwordx4 v4, s[40:43], s67 offen lds
    s_add_u32 m0, s70, 134144
    s_add_u32 s67, s65, 67584
    buffer_load_dwordx4 v11, s[40:43], s67 offen lds
    s_add_u32 m0, s70, 147456
    s_add_u32 s67, s66, 0
    buffer_load_dwordx4 v2, s[44:47], s67 offen lds
    s_add_u32 m0, s70, 148480
    s_add_u32 s67, s66, 8192
    buffer_load_dwordx4 v3, s[44:47], s67 offen lds
    s_add_u32 m0, s70, 149504
    s_add_u32 s67, s66, 16384
    buffer_load_dwordx4 v2, s[44:47], s67 offen lds
    s_add_u32 m0, s70, 150528
    s_add_u32 s67, s66, 24576
    buffer_load_dwordx4 v3, s[44:47], s67 offen lds
    s_load_dwordx2 s[78:79], s[30:31], 128
    s_waitcnt vmcnt(8)
    s_barrier
    s_add_u32 s64, s39, 5
    s_and_b32 s64, s64, 7
    s_lshl_b32 s65, s64, 7
    s_add_u32 s65, s65, s68
    s_lshl_b32 s66, s64, 7
    s_add_u32 s66, s66, s69
    s_add_u32 m0, s70, 0
    s_add_u32 s67, s65, 0
    buffer_load_dwordx4 v4, s[40:43], s67 offen lds
    s_add_u32 m0, s70, 1024
    s_add_u32 s67, s65, 65536
    buffer_load_dwordx4 v11, s[40:43], s67 offen lds
    s_add_u32 m0, s70, 2048
    s_add_u32 s67, s65, 2048
    buffer_load_dwordx4 v4, s[40:43], s67 offen lds
    s_add_u32 m0, s70, 3072
    s_add_u32 s67, s65, 67584
    buffer_load_dwordx4 v11, s[40:43], s67 offen lds
    s_add_u32 m0, s70, 16384
    s_add_u32 s67, s66, 0
    buffer_load_dwordx4 v2, s[44:47], s67 offen lds
    s_add_u32 m0, s70, 17408
    s_add_u32 s67, s66, 8192
    buffer_load_dwordx4 v3, s[44:47], s67 offen lds
    s_add_u32 m0, s70, 18432
    s_add_u32 s67, s66, 16384
    buffer_load_dwordx4 v2, s[44:47], s67 offen lds
    s_add_u32 m0, s70, 19456
    s_add_u32 s67, s66, 24576
    buffer_load_dwordx4 v3, s[44:47], s67 offen lds
    s_waitcnt vmcnt(8)
    s_waitcnt lgkmcnt(0)
    s_cmp_lg_u32 s78, 0
    s_cbranch_scc1 concat_heads__linear_attn_block__ssm_conv_s5__prompt_kernel_nok_bu
    s_mov_b32 s52, s30
    s_and_b32 s53, s31, 0xffff
    s_mov_b32 s54, 0x100
    s_mov_b32 s55, 0x20000
    s_mov_b32 s72, 262144
    v_mov_b32 v13, 0
concat_heads__linear_attn_block__ssm_conv_s5__prompt_kernel_nlp_bu:
    buffer_load_dwordx2 v[14:15], v13, s[52:55], 0 offen offset:128 sc1
    s_waitcnt vmcnt(0)
    v_readfirstlane_b32 s78, v14
    v_readfirstlane_b32 s79, v15
    s_nop 3
    s_sub_u32 s72, s72, 1
    s_cbranch_scc1 concat_heads__linear_attn_block__ssm_conv_s5__prompt_kernel_nok_bu
    s_cmp_lg_u32 s78, 0
    s_cbranch_scc1 concat_heads__linear_attn_block__ssm_conv_s5__prompt_kernel_nok_bu
    s_sleep 2
    s_branch concat_heads__linear_attn_block__ssm_conv_s5__prompt_kernel_nlp_bu
concat_heads__linear_attn_block__ssm_conv_s5__prompt_kernel_nok_bu:
    s_add_u32 s64, s37, 16
    s_lshl_b32 s64, s64, 7
    s_add_u32 s64, s64, 7733248
    s_lshl_b32 s65, s38, 4
    s_add_u32 s64, s64, s65
    s_getreg_b32 s65, hwreg(HW_REG_XCC_ID, 0, 4)
    v_mov_b32 v16, s78
    v_mov_b32 v17, s79
    v_mov_b32 v18, s65
    v_mov_b32 v19, 0
    v_mov_b32 v13, 0
    buffer_store_dwordx4 v[16:19], v13, s[48:51], s64 offen sc1
    s_barrier
    s_add_u32 s64, s39, 6
    s_and_b32 s64, s64, 7
    s_lshl_b32 s65, s64, 7
    s_add_u32 s65, s65, s68
    s_lshl_b32 s66, s64, 7
    s_add_u32 s66, s66, s69
    s_add_u32 m0, s70, 32768
    s_add_u32 s67, s65, 0
    buffer_load_dwordx4 v4, s[40:43], s67 offen lds
    s_add_u32 m0, s70, 33792
    s_add_u32 s67, s65, 65536
    buffer_load_dwordx4 v11, s[40:43], s67 offen lds
    s_add_u32 m0, s70, 34816
    s_add_u32 s67, s65, 2048
    buffer_load_dwordx4 v4, s[40:43], s67 offen lds
    s_add_u32 m0, s70, 35840
    s_add_u32 s67, s65, 67584
    buffer_load_dwordx4 v11, s[40:43], s67 offen lds
    s_add_u32 m0, s70, 49152
    s_add_u32 s67, s66, 0
    buffer_load_dwordx4 v2, s[44:47], s67 offen lds
    s_add_u32 m0, s70, 50176
    s_add_u32 s67, s66, 8192
    buffer_load_dwordx4 v3, s[44:47], s67 offen lds
    s_add_u32 m0, s70, 51200
    s_add_u32 s67, s66, 16384
    buffer_load_dwordx4 v2, s[44:47], s67 offen lds
    s_add_u32 m0, s70, 52224
    s_add_u32 s67, s66, 24576
    buffer_load_dwordx4 v3, s[44:47], s67 offen lds
    s_waitcnt vmcnt(9)
    s_barrier
    s_add_u32 s64, s39, 7
    s_and_b32 s64, s64, 7
    s_lshl_b32 s65, s64, 7
    s_add_u32 s65, s65, s68
    s_lshl_b32 s66, s64, 7
    s_add_u32 s66, s66, s69
    s_add_u32 m0, s70, 65536
    s_add_u32 s67, s65, 0
    buffer_load_dwordx4 v4, s[40:43], s67 offen lds
    s_add_u32 m0, s70, 66560
    s_add_u32 s67, s65, 65536
    buffer_load_dwordx4 v11, s[40:43], s67 offen lds
    s_add_u32 m0, s70, 67584
    s_add_u32 s67, s65, 2048
    buffer_load_dwordx4 v4, s[40:43], s67 offen lds
    s_add_u32 m0, s70, 68608
    s_add_u32 s67, s65, 67584
    buffer_load_dwordx4 v11, s[40:43], s67 offen lds
    s_add_u32 m0, s70, 81920
    s_add_u32 s67, s66, 0
    buffer_load_dwordx4 v2, s[44:47], s67 offen lds
    s_add_u32 m0, s70, 82944
    s_add_u32 s67, s66, 8192
    buffer_load_dwordx4 v3, s[44:47], s67 offen lds
    s_add_u32 m0, s70, 83968
    s_add_u32 s67, s66, 16384
    buffer_load_dwordx4 v2, s[44:47], s67 offen lds
    s_add_u32 m0, s70, 84992
    s_add_u32 s67, s66, 24576
    buffer_load_dwordx4 v3, s[44:47], s67 offen lds
    v_lshlrev_b32 v13, 7, v0
    s_lshl_b32 s64, s37, 2
    s_add_u32 s64, s64, s3
    s_lshl_b32 s64, s64, 6
    s_lshl_b32 s65, s38, 3
    s_add_u32 s64, s64, s65
    s_lshl_b32 s64, s64, 10
    s_add_u32 s64, s64, 2097152
    buffer_load_dword v250, v13, s[48:51], s64 offen sc1
    s_waitcnt vmcnt(9)
    s_barrier
    s_waitcnt vmcnt(1)
    v_mov_b32 v14, s78
    v_mov_b32 v15, s79
    v_mov_b32 v13, 155712
    ds_write_b64 v13, v[14:15]
    s_waitcnt lgkmcnt(0)
    s_barrier
    s_mov_b32 s52, s20
    s_and_b32 s53, s21, 0xffff
    s_mov_b32 s54, 0x80000
    s_mov_b32 s55, 0x20000
    s_lshl_b32 s64, s38, 6
    s_lshl_b32 s65, s3, 3
    s_add_u32 s64, s64, s65
    s_add_u32 s64, s64, 0
    s_lshl_b32 s64, s64, 10
    s_and_b32 s66, s3, 1
    s_lshl_b32 s66, s66, 7
    v_lshlrev_b32 v13, 4, v0
    v_xor_b32 v13, s66, v13
    v_xor_b32 v14, 0, v13
    s_add_u32 s67, s64, 0
    buffer_load_dwordx4 v[24:27], v14, s[52:55], s67 offen
    v_xor_b32 v15, 16, v13
    s_add_u32 s67, s64, 1024
    buffer_load_dwordx4 v[28:31], v15, s[52:55], s67 offen
    v_xor_b32 v14, 32, v13
    s_add_u32 s67, s64, 2048
    buffer_load_dwordx4 v[32:35], v14, s[52:55], s67 offen
    v_xor_b32 v15, 48, v13
    s_add_u32 s67, s64, 3072
    buffer_load_dwordx4 v[36:39], v15, s[52:55], s67 offen
    v_xor_b32 v14, 64, v13
    s_add_u32 s67, s64, 4096
    buffer_load_dwordx4 v[40:43], v14, s[52:55], s67 offen
    v_xor_b32 v15, 80, v13
    s_add_u32 s67, s64, 5120
    buffer_load_dwordx4 v[44:47], v15, s[52:55], s67 offen
    v_xor_b32 v14, 96, v13
    s_add_u32 s67, s64, 6144
    buffer_load_dwordx4 v[48:51], v14, s[52:55], s67 offen
    v_xor_b32 v15, 112, v13
    s_add_u32 s67, s64, 7168
    buffer_load_dwordx4 v[52:55], v15, s[52:55], s67 offen
    s_mov_b32 s52, s20
    s_and_b32 s53, s21, 0xffff
    s_mov_b32 s54, 0x80000
    s_mov_b32 s55, 0x20000
    s_lshl_b32 s64, s38, 6
    s_lshl_b32 s65, s3, 3
    s_add_u32 s64, s64, s65
    s_add_u32 s64, s64, 32
    s_lshl_b32 s64, s64, 10
    s_and_b32 s66, s3, 1
    s_lshl_b32 s66, s66, 7
    v_lshlrev_b32 v13, 4, v0
    v_xor_b32 v13, s66, v13
    v_xor_b32 v14, 0, v13
    s_add_u32 s67, s64, 0
    buffer_load_dwordx4 v[56:59], v14, s[52:55], s67 offen
    v_xor_b32 v15, 16, v13
    s_add_u32 s67, s64, 1024
    buffer_load_dwordx4 v[60:63], v15, s[52:55], s67 offen
    v_xor_b32 v14, 32, v13
    s_add_u32 s67, s64, 2048
    buffer_load_dwordx4 v[64:67], v14, s[52:55], s67 offen
    v_xor_b32 v15, 48, v13
    s_add_u32 s67, s64, 3072
    buffer_load_dwordx4 v[68:71], v15, s[52:55], s67 offen
    v_xor_b32 v14, 64, v13
    s_add_u32 s67, s64, 4096
    buffer_load_dwordx4 v[72:75], v14, s[52:55], s67 offen
    v_xor_b32 v15, 80, v13
    s_add_u32 s67, s64, 5120
    buffer_load_dwordx4 v[76:79], v15, s[52:55], s67 offen
    v_xor_b32 v14, 96, v13
    s_add_u32 s67, s64, 6144
    buffer_load_dwordx4 v[80:83], v14, s[52:55], s67 offen
    v_xor_b32 v15, 112, v13
    s_add_u32 s67, s64, 7168
    buffer_load_dwordx4 v[84:87], v15, s[52:55], s67 offen
    s_barrier
    s_mov_b32 s52, s22
    s_and_b32 s53, s23, 0xffff
    s_mov_b32 s54, 0x80000
    s_mov_b32 s55, 0x20000
    s_lshl_b32 s64, s38, 6
    s_lshl_b32 s65, s3, 3
    s_add_u32 s64, s64, s65
    s_add_u32 s64, s64, 0
    s_lshl_b32 s64, s64, 10
    s_and_b32 s66, s3, 1
    s_lshl_b32 s66, s66, 7
    v_lshlrev_b32 v13, 4, v0
    v_xor_b32 v13, s66, v13
    v_xor_b32 v14, 0, v13
    s_add_u32 s67, s64, 0
    buffer_load_dwordx4 v[88:91], v14, s[52:55], s67 offen
    v_xor_b32 v15, 16, v13
    s_add_u32 s67, s64, 1024
    buffer_load_dwordx4 v[92:95], v15, s[52:55], s67 offen
    v_xor_b32 v14, 32, v13
    s_add_u32 s67, s64, 2048
    buffer_load_dwordx4 v[96:99], v14, s[52:55], s67 offen
    v_xor_b32 v15, 48, v13
    s_add_u32 s67, s64, 3072
    buffer_load_dwordx4 v[100:103], v15, s[52:55], s67 offen
    v_xor_b32 v14, 64, v13
    s_add_u32 s67, s64, 4096
    buffer_load_dwordx4 v[104:107], v14, s[52:55], s67 offen
    v_xor_b32 v15, 80, v13
    s_add_u32 s67, s64, 5120
    buffer_load_dwordx4 v[108:111], v15, s[52:55], s67 offen
    v_xor_b32 v14, 96, v13
    s_add_u32 s67, s64, 6144
    buffer_load_dwordx4 v[160:163], v14, s[52:55], s67 offen
    v_xor_b32 v15, 112, v13
    s_add_u32 s67, s64, 7168
    buffer_load_dwordx4 v[164:167], v15, s[52:55], s67 offen
    s_mov_b32 s52, s22
    s_and_b32 s53, s23, 0xffff
    s_mov_b32 s54, 0x80000
    s_mov_b32 s55, 0x20000
    s_lshl_b32 s64, s38, 6
    s_lshl_b32 s65, s3, 3
    s_add_u32 s64, s64, s65
    s_add_u32 s64, s64, 32
    s_lshl_b32 s64, s64, 10
    s_and_b32 s66, s3, 1
    s_lshl_b32 s66, s66, 7
    v_lshlrev_b32 v13, 4, v0
    v_xor_b32 v13, s66, v13
    v_xor_b32 v14, 0, v13
    s_add_u32 s67, s64, 0
    buffer_load_dwordx4 v[168:171], v14, s[52:55], s67 offen
    v_xor_b32 v15, 16, v13
    s_add_u32 s67, s64, 1024
    buffer_load_dwordx4 v[172:175], v15, s[52:55], s67 offen
    v_xor_b32 v14, 32, v13
    s_add_u32 s67, s64, 2048
    buffer_load_dwordx4 v[176:179], v14, s[52:55], s67 offen
    v_xor_b32 v15, 48, v13
    s_add_u32 s67, s64, 3072
    buffer_load_dwordx4 v[180:183], v15, s[52:55], s67 offen
    v_xor_b32 v14, 64, v13
    s_add_u32 s67, s64, 4096
    buffer_load_dwordx4 v[184:187], v14, s[52:55], s67 offen
    v_xor_b32 v15, 80, v13
    s_add_u32 s67, s64, 5120
    buffer_load_dwordx4 v[188:191], v15, s[52:55], s67 offen
    v_xor_b32 v14, 96, v13
    s_add_u32 s67, s64, 6144
    buffer_load_dwordx4 v[192:195], v14, s[52:55], s67 offen
    v_xor_b32 v15, 112, v13
    s_add_u32 s67, s64, 7168
    buffer_load_dwordx4 v[196:199], v15, s[52:55], s67 offen
    s_lshr_b32 s64, s34, 2
    s_lshl_b32 s68, s37, 7
    s_lshl_b32 s69, s3, 5
    s_add_u32 s68, s68, s69
    s_lshl_b32 s69, s38, 6
    s_lshl_b32 s70, s64, 5
    s_add_u32 s69, s69, s70
    s_mov_b32 s52, s10
    s_and_b32 s53, s11, 0xffff
    s_mov_b32 s54, 0x200000
    s_mov_b32 s55, 0x20000
    s_mov_b32 s56, s26
    s_and_b32 s57, s27, 0xffff
    s_mov_b32 s58, 0x400
    s_mov_b32 s59, 0x20000
    s_lshl_b32 s70, s68, 10
    s_lshl_b32 s71, s69, 1
    s_add_u32 s70, s70, s71
    v_and_b32 v8, 31, v0
    v_lshrrev_b32 v7, 5, v0
    v_lshlrev_b32 v7, 12, v7
    v_lshlrev_b32 v8, 1, v8
    v_add_u32 v7, v7, v8
    buffer_load_ushort v112, v7, s[52:55], s70 offen offset:0
    buffer_load_ushort v113, v7, s[52:55], s70 offen offset:1024
    buffer_load_ushort v114, v7, s[52:55], s70 offen offset:2048
    buffer_load_ushort v115, v7, s[52:55], s70 offen offset:3072
    s_add_u32 s70, s70, 8192
    buffer_load_ushort v116, v7, s[52:55], s70 offen offset:0
    buffer_load_ushort v117, v7, s[52:55], s70 offen offset:1024
    buffer_load_ushort v118, v7, s[52:55], s70 offen offset:2048
    buffer_load_ushort v119, v7, s[52:55], s70 offen offset:3072
    s_add_u32 s70, s70, 8192
    buffer_load_ushort v120, v7, s[52:55], s70 offen offset:0
    buffer_load_ushort v121, v7, s[52:55], s70 offen offset:1024
    buffer_load_ushort v122, v7, s[52:55], s70 offen offset:2048
    buffer_load_ushort v123, v7, s[52:55], s70 offen offset:3072
    s_add_u32 s70, s70, 8192
    buffer_load_ushort v124, v7, s[52:55], s70 offen offset:0
    buffer_load_ushort v125, v7, s[52:55], s70 offen offset:1024
    buffer_load_ushort v126, v7, s[52:55], s70 offen offset:2048
    buffer_load_ushort v127, v7, s[52:55], s70 offen offset:3072
    buffer_load_ushort v239, v8, s[56:59], s71 offen
    v_lshlrev_b32 v13, 4, v0
    s_lshl_b32 s65, s3, 13
    v_add_u32 v13, s65, v13
    s_waitcnt vmcnt(41)
    ds_write_b128 v13, v[24:27] offset:0
    ds_write_b128 v13, v[28:31] offset:1024
    ds_write_b128 v13, v[32:35] offset:2048
    ds_write_b128 v13, v[36:39] offset:3072
    ds_write_b128 v13, v[40:43] offset:4096
    ds_write_b128 v13, v[44:47] offset:5120
    ds_write_b128 v13, v[48:51] offset:6144
    ds_write_b128 v13, v[52:55] offset:7168
    s_waitcnt vmcnt(33)
    ds_write_b128 v13, v[56:59] offset:32768
    ds_write_b128 v13, v[60:63] offset:33792
    ds_write_b128 v13, v[64:67] offset:34816
    ds_write_b128 v13, v[68:71] offset:35840
    ds_write_b128 v13, v[72:75] offset:36864
    ds_write_b128 v13, v[76:79] offset:37888
    ds_write_b128 v13, v[80:83] offset:38912
    ds_write_b128 v13, v[84:87] offset:39936
    s_waitcnt vmcnt(25)
    v_add_u32 v13, 0x10000, v13
    ds_write_b128 v13, v[88:91] offset:0
    ds_write_b128 v13, v[92:95] offset:1024
    ds_write_b128 v13, v[96:99] offset:2048
    ds_write_b128 v13, v[100:103] offset:3072
    ds_write_b128 v13, v[104:107] offset:4096
    ds_write_b128 v13, v[108:111] offset:5120
    ds_write_b128 v13, v[160:163] offset:6144
    ds_write_b128 v13, v[164:167] offset:7168
    s_waitcnt vmcnt(17)
    ds_write_b128 v13, v[168:171] offset:32768
    ds_write_b128 v13, v[172:175] offset:33792
    ds_write_b128 v13, v[176:179] offset:34816
    ds_write_b128 v13, v[180:183] offset:35840
    ds_write_b128 v13, v[184:187] offset:36864
    ds_write_b128 v13, v[188:191] offset:37888
    ds_write_b128 v13, v[192:195] offset:38912
    ds_write_b128 v13, v[196:199] offset:39936
    s_waitcnt lgkmcnt(0)
    s_waitcnt vmcnt(0)
    v_lshlrev_b32 v239, 16, v239
    v_lshlrev_b32 v112, 16, v112
    v_lshlrev_b32 v113, 16, v113
    v_lshlrev_b32 v114, 16, v114
    v_lshlrev_b32 v115, 16, v115
    v_lshlrev_b32 v116, 16, v116
    v_lshlrev_b32 v117, 16, v117
    v_lshlrev_b32 v118, 16, v118
    v_lshlrev_b32 v119, 16, v119
    v_lshlrev_b32 v120, 16, v120
    v_lshlrev_b32 v121, 16, v121
    v_lshlrev_b32 v122, 16, v122
    v_lshlrev_b32 v123, 16, v123
    v_lshlrev_b32 v124, 16, v124
    v_lshlrev_b32 v125, 16, v125
    v_lshlrev_b32 v126, 16, v126
    v_lshlrev_b32 v127, 16, v127
    v_mul_f32 v112, v112, v239
    v_mul_f32 v113, v113, v239
    v_mul_f32 v114, v114, v239
    v_mul_f32 v115, v115, v239
    v_mul_f32 v116, v116, v239
    v_mul_f32 v117, v117, v239
    v_mul_f32 v118, v118, v239
    v_mul_f32 v119, v119, v239
    v_mul_f32 v120, v120, v239
    v_mul_f32 v121, v121, v239
    v_mul_f32 v122, v122, v239
    v_mul_f32 v123, v123, v239
    v_mul_f32 v124, v124, v239
    v_mul_f32 v125, v125, v239
    v_mul_f32 v126, v126, v239
    v_mul_f32 v127, v127, v239
    v_cvt_pk_bf16_f32 v112, v112, v113
    v_cvt_pk_bf16_f32 v114, v114, v115
    v_cvt_pk_bf16_f32 v116, v116, v117
    v_cvt_pk_bf16_f32 v118, v118, v119
    v_cvt_pk_bf16_f32 v120, v120, v121
    v_cvt_pk_bf16_f32 v122, v122, v123
    v_cvt_pk_bf16_f32 v124, v124, v125
    v_cvt_pk_bf16_f32 v126, v126, v127
    v_and_b32 v113, 0xffff0000, v112
    v_lshlrev_b32 v112, 16, v112
    v_and_b32 v115, 0xffff0000, v114
    v_lshlrev_b32 v114, 16, v114
    v_and_b32 v117, 0xffff0000, v116
    v_lshlrev_b32 v116, 16, v116
    v_and_b32 v119, 0xffff0000, v118
    v_lshlrev_b32 v118, 16, v118
    v_and_b32 v121, 0xffff0000, v120
    v_lshlrev_b32 v120, 16, v120
    v_and_b32 v123, 0xffff0000, v122
    v_lshlrev_b32 v122, 16, v122
    v_and_b32 v125, 0xffff0000, v124
    v_lshlrev_b32 v124, 16, v124
    v_and_b32 v127, 0xffff0000, v126
    v_lshlrev_b32 v126, 16, v126
    v_mov_b32 v128, 0
    v_mov_b32 v144, v112
    v_mov_b32 v129, 0
    v_mov_b32 v145, v113
    v_mov_b32 v130, 0
    v_mov_b32 v146, v114
    v_mov_b32 v131, 0
    v_mov_b32 v147, v115
    v_mov_b32 v132, 0
    v_mov_b32 v148, v116
    v_mov_b32 v133, 0
    v_mov_b32 v149, v117
    v_mov_b32 v134, 0
    v_mov_b32 v150, v118
    v_mov_b32 v135, 0
    v_mov_b32 v151, v119
    v_mov_b32 v136, 0
    v_mov_b32 v152, v120
    v_mov_b32 v137, 0
    v_mov_b32 v153, v121
    v_mov_b32 v138, 0
    v_mov_b32 v154, v122
    v_mov_b32 v139, 0
    v_mov_b32 v155, v123
    v_mov_b32 v140, 0
    v_mov_b32 v156, v124
    v_mov_b32 v141, 0
    v_mov_b32 v157, v125
    v_mov_b32 v142, 0
    v_mov_b32 v158, v126
    v_mov_b32 v143, 0
    v_mov_b32 v159, v127
    s_barrier
concat_heads__linear_attn_block__ssm_conv_s5__prompt_kernel_p2B:
    s_lshr_b32 s64, s34, 2
    s_and_b32 s65, s34, 3
    v_lshlrev_b32 v2, 4, v0
    s_lshl_b32 s66, s37, 2
    s_add_u32 s66, s66, s65
    s_mul_i32 s66, s66, 65536
    s_mul_i32 s67, s64, 32768
    s_add_u32 s66, s66, s67
    s_add_u32 s66, s66, 2097152
    v_and_b32 v5, 31, v0
    v_lshrrev_b32 v6, 5, v0
    s_lshl_b32 s68, s37, 7
    s_lshl_b32 s69, s65, 5
    s_add_u32 s68, s68, s69
    s_lshl_b32 s69, s38, 6
    s_lshl_b32 s70, s64, 5
    s_add_u32 s69, s69, s70
    v_lshlrev_b32 v12, 16, v6
    v_lshlrev_b32 v13, 10, v5
    v_add_u32 v12, v12, v13
    v_and_b32 v13, 15, v5
    v_lshlrev_b32 v13, 4, v13
    v_add_u32 v12, v12, v13
    s_lshl_b32 s70, s64, 9
    v_add_u32 v3, s70, v12
    v_xor_b32 v8, 0, v3
    ds_read_b128 v[48:51], v8 offset:0
    ds_read_b128 v[52:55], v8 offset:32768
    v_xor_b32 v9, 16, v3
    ds_read_b128 v[56:59], v9 offset:0
    ds_read_b128 v[60:63], v9 offset:32768
    v_xor_b32 v10, 32, v3
    ds_read_b128 v[64:67], v10 offset:0
    ds_read_b128 v[68:71], v10 offset:32768
    s_mov_b32 s76, s64
    s_mov_b32 s77, s66
    s_add_u32 s64, s37, 16
    s_lshl_b32 s64, s64, 10
    s_add_u32 s64, s64, 7602176
    s_lshr_b32 s65, s34, 2
    s_lshl_b32 s65, s65, 9
    s_add_u32 s64, s64, s65
    s_mov_b32 s72, 262144
    v_lshrrev_b32 v10, 2, v0
    v_lshlrev_b32 v10, 7, v10
    v_and_b32 v11, 3, v0
    v_lshlrev_b32 v11, 3, v11
    v_add_u32 v10, v10, v11
    s_mov_b64 s[74:75], exec
    s_mov_b64 exec, 0xffff
concat_heads__linear_attn_block__ssm_conv_s5__prompt_kernel_fpoll_B:
    buffer_load_dwordx2 v[8:9], v10, s[48:51], s64 offen sc1
    s_waitcnt vmcnt(0)
    v_xor_b32 v8, s78, v8
    v_xor_b32 v9, s79, v9
    v_or_b32 v8, v8, v9
    v_cmp_ne_u32 vcc, 0, v8
    s_sub_u32 s72, s72, 1
    s_cbranch_scc1 concat_heads__linear_attn_block__ssm_conv_s5__prompt_kernel_fpolld_B
    s_cbranch_vccz concat_heads__linear_attn_block__ssm_conv_s5__prompt_kernel_fpolld_B
    s_branch concat_heads__linear_attn_block__ssm_conv_s5__prompt_kernel_fpoll_B
concat_heads__linear_attn_block__ssm_conv_s5__prompt_kernel_fpolld_B:
    s_mov_b64 exec, s[74:75]
    s_mov_b32 s64, s76
    s_mov_b32 s66, s77
    buffer_load_dwordx4 v[80:83], v2, s[48:51], s66 offen offset:0
    buffer_load_dwordx4 v[84:87], v2, s[48:51], s66 offen offset:1024
    buffer_load_dwordx4 v[88:91], v2, s[48:51], s66 offen offset:2048
    buffer_load_dwordx4 v[92:95], v2, s[48:51], s66 offen offset:3072
    s_add_u32 s66, s66, 4096
    buffer_load_dwordx4 v[96:99], v2, s[48:51], s66 offen offset:0
    buffer_load_dwordx4 v[100:103], v2, s[48:51], s66 offen offset:1024
    buffer_load_dwordx4 v[104:107], v2, s[48:51], s66 offen offset:2048
    buffer_load_dwordx4 v[108:111], v2, s[48:51], s66 offen offset:3072
    s_add_u32 s66, s66, 4096
    v_xor_b32 v11, 48, v3
    ds_read_b128 v[72:75], v11 offset:0
    ds_read_b128 v[76:79], v11 offset:32768
    s_waitcnt vmcnt(7)
    s_waitcnt lgkmcnt(6)
    v_mfma_f32_32x32x16_bf16 v[128:143], v[80:83], v[48:51], v[128:143]
    v_mfma_f32_32x32x16_bf16 v[144:159], v[80:83], v[52:55], v[144:159]
    buffer_load_dwordx4 v[80:83], v2, s[48:51], s66 offen offset:0
    v_xor_b32 v8, 64, v3
    ds_read_b128 v[48:51], v8 offset:0
    ds_read_b128 v[52:55], v8 offset:32768
    s_waitcnt vmcnt(7)
    s_waitcnt lgkmcnt(6)
    v_mfma_f32_32x32x16_bf16 v[128:143], v[84:87], v[56:59], v[128:143]
    v_mfma_f32_32x32x16_bf16 v[144:159], v[84:87], v[60:63], v[144:159]
    buffer_load_dwordx4 v[84:87], v2, s[48:51], s66 offen offset:1024
    v_xor_b32 v9, 80, v3
    ds_read_b128 v[56:59], v9 offset:0
    ds_read_b128 v[60:63], v9 offset:32768
    s_waitcnt vmcnt(7)
    s_waitcnt lgkmcnt(6)
    v_mfma_f32_32x32x16_bf16 v[128:143], v[88:91], v[64:67], v[128:143]
    v_mfma_f32_32x32x16_bf16 v[144:159], v[88:91], v[68:71], v[144:159]
    buffer_load_dwordx4 v[88:91], v2, s[48:51], s66 offen offset:2048
    v_xor_b32 v10, 96, v3
    ds_read_b128 v[64:67], v10 offset:0
    ds_read_b128 v[68:71], v10 offset:32768
    s_waitcnt vmcnt(7)
    s_waitcnt lgkmcnt(6)
    v_mfma_f32_32x32x16_bf16 v[128:143], v[92:95], v[72:75], v[128:143]
    v_mfma_f32_32x32x16_bf16 v[144:159], v[92:95], v[76:79], v[144:159]
    buffer_load_dwordx4 v[92:95], v2, s[48:51], s66 offen offset:3072
    s_add_u32 s66, s66, 4096
    v_xor_b32 v11, 112, v3
    ds_read_b128 v[72:75], v11 offset:0
    ds_read_b128 v[76:79], v11 offset:32768
    s_waitcnt vmcnt(7)
    s_waitcnt lgkmcnt(6)
    v_mfma_f32_32x32x16_bf16 v[128:143], v[96:99], v[48:51], v[128:143]
    v_mfma_f32_32x32x16_bf16 v[144:159], v[96:99], v[52:55], v[144:159]
    buffer_load_dwordx4 v[96:99], v2, s[48:51], s66 offen offset:0
    v_xor_b32 v8, 128, v3
    ds_read_b128 v[48:51], v8 offset:0
    ds_read_b128 v[52:55], v8 offset:32768
    s_waitcnt vmcnt(7)
    s_waitcnt lgkmcnt(6)
    v_mfma_f32_32x32x16_bf16 v[128:143], v[100:103], v[56:59], v[128:143]
    v_mfma_f32_32x32x16_bf16 v[144:159], v[100:103], v[60:63], v[144:159]
    buffer_load_dwordx4 v[100:103], v2, s[48:51], s66 offen offset:1024
    v_xor_b32 v9, 144, v3
    ds_read_b128 v[56:59], v9 offset:0
    ds_read_b128 v[60:63], v9 offset:32768
    s_waitcnt vmcnt(7)
    s_waitcnt lgkmcnt(6)
    v_mfma_f32_32x32x16_bf16 v[128:143], v[104:107], v[64:67], v[128:143]
    v_mfma_f32_32x32x16_bf16 v[144:159], v[104:107], v[68:71], v[144:159]
    buffer_load_dwordx4 v[104:107], v2, s[48:51], s66 offen offset:2048
    v_xor_b32 v10, 160, v3
    ds_read_b128 v[64:67], v10 offset:0
    ds_read_b128 v[68:71], v10 offset:32768
    s_waitcnt vmcnt(7)
    s_waitcnt lgkmcnt(6)
    v_mfma_f32_32x32x16_bf16 v[128:143], v[108:111], v[72:75], v[128:143]
    v_mfma_f32_32x32x16_bf16 v[144:159], v[108:111], v[76:79], v[144:159]
    buffer_load_dwordx4 v[108:111], v2, s[48:51], s66 offen offset:3072
    s_add_u32 s66, s66, 4096
    v_xor_b32 v11, 176, v3
    ds_read_b128 v[72:75], v11 offset:0
    ds_read_b128 v[76:79], v11 offset:32768
    s_waitcnt vmcnt(7)
    s_waitcnt lgkmcnt(6)
    v_mfma_f32_32x32x16_bf16 v[128:143], v[80:83], v[48:51], v[128:143]
    v_mfma_f32_32x32x16_bf16 v[144:159], v[80:83], v[52:55], v[144:159]
    buffer_load_dwordx4 v[80:83], v2, s[48:51], s66 offen offset:0
    v_xor_b32 v8, 192, v3
    ds_read_b128 v[48:51], v8 offset:0
    ds_read_b128 v[52:55], v8 offset:32768
    s_waitcnt vmcnt(7)
    s_waitcnt lgkmcnt(6)
    v_mfma_f32_32x32x16_bf16 v[128:143], v[84:87], v[56:59], v[128:143]
    v_mfma_f32_32x32x16_bf16 v[144:159], v[84:87], v[60:63], v[144:159]
    buffer_load_dwordx4 v[84:87], v2, s[48:51], s66 offen offset:1024
    v_xor_b32 v9, 208, v3
    ds_read_b128 v[56:59], v9 offset:0
    ds_read_b128 v[60:63], v9 offset:32768
    s_waitcnt vmcnt(7)
    s_waitcnt lgkmcnt(6)
    v_mfma_f32_32x32x16_bf16 v[128:143], v[88:91], v[64:67], v[128:143]
    v_mfma_f32_32x32x16_bf16 v[144:159], v[88:91], v[68:71], v[144:159]
    buffer_load_dwordx4 v[88:91], v2, s[48:51], s66 offen offset:2048
    v_xor_b32 v10, 224, v3
    ds_read_b128 v[64:67], v10 offset:0
    ds_read_b128 v[68:71], v10 offset:32768
    s_waitcnt vmcnt(7)
    s_waitcnt lgkmcnt(6)
    v_mfma_f32_32x32x16_bf16 v[128:143], v[92:95], v[72:75], v[128:143]
    v_mfma_f32_32x32x16_bf16 v[144:159], v[92:95], v[76:79], v[144:159]
    buffer_load_dwordx4 v[92:95], v2, s[48:51], s66 offen offset:3072
    s_add_u32 s66, s66, 4096
    v_xor_b32 v11, 240, v3
    ds_read_b128 v[72:75], v11 offset:0
    ds_read_b128 v[76:79], v11 offset:32768
    s_waitcnt vmcnt(7)
    s_waitcnt lgkmcnt(6)
    v_mfma_f32_32x32x16_bf16 v[128:143], v[96:99], v[48:51], v[128:143]
    v_mfma_f32_32x32x16_bf16 v[144:159], v[96:99], v[52:55], v[144:159]
    buffer_load_dwordx4 v[96:99], v2, s[48:51], s66 offen offset:0
    v_xor_b32 v8, 0, v3
    ds_read_b128 v[48:51], v8 offset:256
    ds_read_b128 v[52:55], v8 offset:33024
    s_waitcnt vmcnt(7)
    s_waitcnt lgkmcnt(6)
    v_mfma_f32_32x32x16_bf16 v[128:143], v[100:103], v[56:59], v[128:143]
    v_mfma_f32_32x32x16_bf16 v[144:159], v[100:103], v[60:63], v[144:159]
    buffer_load_dwordx4 v[100:103], v2, s[48:51], s66 offen offset:1024
    v_xor_b32 v9, 16, v3
    ds_read_b128 v[56:59], v9 offset:256
    ds_read_b128 v[60:63], v9 offset:33024
    s_waitcnt vmcnt(7)
    s_waitcnt lgkmcnt(6)
    v_mfma_f32_32x32x16_bf16 v[128:143], v[104:107], v[64:67], v[128:143]
    v_mfma_f32_32x32x16_bf16 v[144:159], v[104:107], v[68:71], v[144:159]
    buffer_load_dwordx4 v[104:107], v2, s[48:51], s66 offen offset:2048
    v_xor_b32 v10, 32, v3
    ds_read_b128 v[64:67], v10 offset:256
    ds_read_b128 v[68:71], v10 offset:33024
    s_waitcnt vmcnt(7)
    s_waitcnt lgkmcnt(6)
    v_mfma_f32_32x32x16_bf16 v[128:143], v[108:111], v[72:75], v[128:143]
    v_mfma_f32_32x32x16_bf16 v[144:159], v[108:111], v[76:79], v[144:159]
    buffer_load_dwordx4 v[108:111], v2, s[48:51], s66 offen offset:3072
    s_add_u32 s66, s66, 4096
    v_xor_b32 v11, 48, v3
    ds_read_b128 v[72:75], v11 offset:256
    ds_read_b128 v[76:79], v11 offset:33024
    s_waitcnt vmcnt(7)
    s_waitcnt lgkmcnt(6)
    v_mfma_f32_32x32x16_bf16 v[128:143], v[80:83], v[48:51], v[128:143]
    v_mfma_f32_32x32x16_bf16 v[144:159], v[80:83], v[52:55], v[144:159]
    buffer_load_dwordx4 v[80:83], v2, s[48:51], s66 offen offset:0
    v_xor_b32 v8, 64, v3
    ds_read_b128 v[48:51], v8 offset:256
    ds_read_b128 v[52:55], v8 offset:33024
    s_waitcnt vmcnt(7)
    s_waitcnt lgkmcnt(6)
    v_mfma_f32_32x32x16_bf16 v[128:143], v[84:87], v[56:59], v[128:143]
    v_mfma_f32_32x32x16_bf16 v[144:159], v[84:87], v[60:63], v[144:159]
    buffer_load_dwordx4 v[84:87], v2, s[48:51], s66 offen offset:1024
    v_xor_b32 v9, 80, v3
    ds_read_b128 v[56:59], v9 offset:256
    ds_read_b128 v[60:63], v9 offset:33024
    s_waitcnt vmcnt(7)
    s_waitcnt lgkmcnt(6)
    v_mfma_f32_32x32x16_bf16 v[128:143], v[88:91], v[64:67], v[128:143]
    v_mfma_f32_32x32x16_bf16 v[144:159], v[88:91], v[68:71], v[144:159]
    buffer_load_dwordx4 v[88:91], v2, s[48:51], s66 offen offset:2048
    v_xor_b32 v10, 96, v3
    ds_read_b128 v[64:67], v10 offset:256
    ds_read_b128 v[68:71], v10 offset:33024
    s_waitcnt vmcnt(7)
    s_waitcnt lgkmcnt(6)
    v_mfma_f32_32x32x16_bf16 v[128:143], v[92:95], v[72:75], v[128:143]
    v_mfma_f32_32x32x16_bf16 v[144:159], v[92:95], v[76:79], v[144:159]
    buffer_load_dwordx4 v[92:95], v2, s[48:51], s66 offen offset:3072
    s_add_u32 s66, s66, 4096
    v_xor_b32 v11, 112, v3
    ds_read_b128 v[72:75], v11 offset:256
    ds_read_b128 v[76:79], v11 offset:33024
    s_waitcnt vmcnt(7)
    s_waitcnt lgkmcnt(6)
    v_mfma_f32_32x32x16_bf16 v[128:143], v[96:99], v[48:51], v[128:143]
    v_mfma_f32_32x32x16_bf16 v[144:159], v[96:99], v[52:55], v[144:159]
    buffer_load_dwordx4 v[96:99], v2, s[48:51], s66 offen offset:0
    v_xor_b32 v8, 128, v3
    ds_read_b128 v[48:51], v8 offset:256
    ds_read_b128 v[52:55], v8 offset:33024
    s_waitcnt vmcnt(7)
    s_waitcnt lgkmcnt(6)
    v_mfma_f32_32x32x16_bf16 v[128:143], v[100:103], v[56:59], v[128:143]
    v_mfma_f32_32x32x16_bf16 v[144:159], v[100:103], v[60:63], v[144:159]
    buffer_load_dwordx4 v[100:103], v2, s[48:51], s66 offen offset:1024
    v_xor_b32 v9, 144, v3
    ds_read_b128 v[56:59], v9 offset:256
    ds_read_b128 v[60:63], v9 offset:33024
    s_waitcnt vmcnt(7)
    s_waitcnt lgkmcnt(6)
    v_mfma_f32_32x32x16_bf16 v[128:143], v[104:107], v[64:67], v[128:143]
    v_mfma_f32_32x32x16_bf16 v[144:159], v[104:107], v[68:71], v[144:159]
    buffer_load_dwordx4 v[104:107], v2, s[48:51], s66 offen offset:2048
    v_xor_b32 v10, 160, v3
    ds_read_b128 v[64:67], v10 offset:256
    ds_read_b128 v[68:71], v10 offset:33024
    s_waitcnt vmcnt(7)
    s_waitcnt lgkmcnt(6)
    v_mfma_f32_32x32x16_bf16 v[128:143], v[108:111], v[72:75], v[128:143]
    v_mfma_f32_32x32x16_bf16 v[144:159], v[108:111], v[76:79], v[144:159]
    buffer_load_dwordx4 v[108:111], v2, s[48:51], s66 offen offset:3072
    s_add_u32 s66, s66, 4096
    v_xor_b32 v11, 176, v3
    ds_read_b128 v[72:75], v11 offset:256
    ds_read_b128 v[76:79], v11 offset:33024
    s_waitcnt vmcnt(7)
    s_waitcnt lgkmcnt(6)
    v_mfma_f32_32x32x16_bf16 v[128:143], v[80:83], v[48:51], v[128:143]
    v_mfma_f32_32x32x16_bf16 v[144:159], v[80:83], v[52:55], v[144:159]
    v_xor_b32 v8, 192, v3
    ds_read_b128 v[48:51], v8 offset:256
    ds_read_b128 v[52:55], v8 offset:33024
    s_waitcnt vmcnt(6)
    s_waitcnt lgkmcnt(6)
    v_mfma_f32_32x32x16_bf16 v[128:143], v[84:87], v[56:59], v[128:143]
    v_mfma_f32_32x32x16_bf16 v[144:159], v[84:87], v[60:63], v[144:159]
    v_xor_b32 v9, 208, v3
    ds_read_b128 v[56:59], v9 offset:256
    ds_read_b128 v[60:63], v9 offset:33024
    s_waitcnt vmcnt(5)
    s_waitcnt lgkmcnt(6)
    v_mfma_f32_32x32x16_bf16 v[128:143], v[88:91], v[64:67], v[128:143]
    v_mfma_f32_32x32x16_bf16 v[144:159], v[88:91], v[68:71], v[144:159]
    v_xor_b32 v10, 224, v3
    ds_read_b128 v[64:67], v10 offset:256
    ds_read_b128 v[68:71], v10 offset:33024
    s_waitcnt vmcnt(4)
    s_waitcnt lgkmcnt(6)
    v_mfma_f32_32x32x16_bf16 v[128:143], v[92:95], v[72:75], v[128:143]
    v_mfma_f32_32x32x16_bf16 v[144:159], v[92:95], v[76:79], v[144:159]
    v_xor_b32 v11, 240, v3
    ds_read_b128 v[72:75], v11 offset:256
    ds_read_b128 v[76:79], v11 offset:33024
    s_waitcnt vmcnt(3)
    s_waitcnt lgkmcnt(6)
    v_mfma_f32_32x32x16_bf16 v[128:143], v[96:99], v[48:51], v[128:143]
    v_mfma_f32_32x32x16_bf16 v[144:159], v[96:99], v[52:55], v[144:159]
    s_waitcnt vmcnt(2)
    s_waitcnt lgkmcnt(4)
    v_mfma_f32_32x32x16_bf16 v[128:143], v[100:103], v[56:59], v[128:143]
    v_mfma_f32_32x32x16_bf16 v[144:159], v[100:103], v[60:63], v[144:159]
    s_waitcnt vmcnt(1)
    s_waitcnt lgkmcnt(2)
    v_mfma_f32_32x32x16_bf16 v[128:143], v[104:107], v[64:67], v[128:143]
    v_mfma_f32_32x32x16_bf16 v[144:159], v[104:107], v[68:71], v[144:159]
    s_waitcnt vmcnt(0)
    s_waitcnt lgkmcnt(0)
    v_mfma_f32_32x32x16_bf16 v[128:143], v[108:111], v[72:75], v[128:143]
    v_mfma_f32_32x32x16_bf16 v[144:159], v[108:111], v[76:79], v[144:159]
    s_lshl_b32 s70, s34, 12
    s_add_u32 s70, s70, 131072
    v_add_u32 v9, s70, v2
    s_xor_b32 s71, s34, 4
    s_lshl_b32 s71, s71, 12
    s_add_u32 s71, s71, 131072
    v_add_u32 v10, s71, v2
    s_lshl_b32 s68, s68, 12
    s_lshl_b32 s69, s69, 2
    s_add_u32 s68, s68, s69
    s_add_u32 s68, s68, 2048
    v_lshlrev_b32 v11, 14, v6
    v_lshlrev_b32 v12, 2, v5
    v_add_u32 v11, v11, v12
    s_mov_b32 s52, s28
    s_and_b32 s53, s29, 0xffff
    s_mov_b32 s54, 0x800000
    s_mov_b32 s55, 0x20000
    s_cmp_eq_u32 s64, 1
    s_cbranch_scc1 concat_heads__linear_attn_block__ssm_conv_s5__prompt_kernel_kh1_B
    ds_write_b128 v9, v[144:147] offset:0
    ds_write_b128 v9, v[148:151] offset:1024
    ds_write_b128 v9, v[152:155] offset:2048
    ds_write_b128 v9, v[156:159] offset:3072
    s_mov_b32 s71, 0
    s_branch concat_heads__linear_attn_block__ssm_conv_s5__prompt_kernel_join_B
concat_heads__linear_attn_block__ssm_conv_s5__prompt_kernel_kh1_B:
    ds_write_b128 v9, v[128:131] offset:0
    ds_write_b128 v9, v[132:135] offset:1024
    ds_write_b128 v9, v[136:139] offset:2048
    ds_write_b128 v9, v[140:143] offset:3072
    s_nop 1
    v_mov_b32 v128, v144
    v_mov_b32 v129, v145
    v_mov_b32 v130, v146
    v_mov_b32 v131, v147
    v_mov_b32 v132, v148
    v_mov_b32 v133, v149
    v_mov_b32 v134, v150
    v_mov_b32 v135, v151
    v_mov_b32 v136, v152
    v_mov_b32 v137, v153
    v_mov_b32 v138, v154
    v_mov_b32 v139, v155
    v_mov_b32 v140, v156
    v_mov_b32 v141, v157
    v_mov_b32 v142, v158
    v_mov_b32 v143, v159
concat_heads__linear_attn_block__ssm_conv_s5__prompt_kernel_join_B:
    s_waitcnt lgkmcnt(0)
    s_barrier
    ds_read_b128 v[48:51], v10 offset:0
    ds_read_b128 v[52:55], v10 offset:1024
    ds_read_b128 v[56:59], v10 offset:2048
    ds_read_b128 v[60:63], v10 offset:3072
    s_waitcnt lgkmcnt(3)
    v_pk_add_f32 v[128:129], v[128:129], v[48:49]
    v_pk_add_f32 v[130:131], v[130:131], v[50:51]
    s_add_u32 s69, s68, 0
    buffer_store_dword v128, v11, s[52:55], s69 offen nt
    s_add_u32 s69, s68, 4096
    buffer_store_dword v129, v11, s[52:55], s69 offen nt
    s_add_u32 s69, s68, 8192
    buffer_store_dword v130, v11, s[52:55], s69 offen nt
    s_add_u32 s69, s68, 12288
    buffer_store_dword v131, v11, s[52:55], s69 offen nt
    s_waitcnt lgkmcnt(2)
    v_pk_add_f32 v[132:133], v[132:133], v[52:53]
    v_pk_add_f32 v[134:135], v[134:135], v[54:55]
    s_add_u32 s69, s68, 32768
    buffer_store_dword v132, v11, s[52:55], s69 offen nt
    s_add_u32 s69, s68, 36864
    buffer_store_dword v133, v11, s[52:55], s69 offen nt
    s_add_u32 s69, s68, 40960
    buffer_store_dword v134, v11, s[52:55], s69 offen nt
    s_add_u32 s69, s68, 45056
    buffer_store_dword v135, v11, s[52:55], s69 offen nt
    s_waitcnt lgkmcnt(1)
    v_pk_add_f32 v[136:137], v[136:137], v[56:57]
    v_pk_add_f32 v[138:139], v[138:139], v[58:59]
    s_add_u32 s69, s68, 65536
    buffer_store_dword v136, v11, s[52:55], s69 offen nt
    s_add_u32 s69, s68, 69632
    buffer_store_dword v137, v11, s[52:55], s69 offen nt
    s_add_u32 s69, s68, 73728
    buffer_store_dword v138, v11, s[52:55], s69 offen nt
    s_add_u32 s69, s68, 77824
    buffer_store_dword v139, v11, s[52:55], s69 offen nt
    s_waitcnt lgkmcnt(0)
    v_pk_add_f32 v[140:141], v[140:141], v[60:61]
    v_pk_add_f32 v[142:143], v[142:143], v[62:63]
    s_add_u32 s69, s68, 98304
    buffer_store_dword v140, v11, s[52:55], s69 offen nt
    s_add_u32 s69, s68, 102400
    buffer_store_dword v141, v11, s[52:55], s69 offen nt
    s_add_u32 s69, s68, 106496
    buffer_store_dword v142, v11, s[52:55], s69 offen nt
    s_add_u32 s69, s68, 110592
    buffer_store_dword v143, v11, s[52:55], s69 offen nt
    s_endpgm
concat_heads__linear_attn_block__ssm_conv_s5__prompt_kernel_compute:
    s_load_dwordx4 s[12:15], s[0:1], 32
    s_load_dwordx4 s[20:23], s[0:1], 64
    s_load_dwordx4 s[24:27], s[0:1], 80
    s_load_dwordx4 s[28:31], s[0:1], 96
    s_load_dwordx2 s[32:33], s[0:1], 112
    s_cmp_ge_u32 s35, 4
    s_cbranch_scc1 concat_heads__linear_attn_block__ssm_conv_s5__prompt_kernel_bu
    s_waitcnt lgkmcnt(0)
    s_cmp_lg_u32 s2, 0
    s_cbranch_scc1 concat_heads__linear_attn_block__ssm_conv_s5__prompt_kernel_nononce
    s_cmp_lg_u32 s34, 0
    s_cbranch_scc1 concat_heads__linear_attn_block__ssm_conv_s5__prompt_kernel_nononce
    s_memrealtime s[70:71]
    s_waitcnt lgkmcnt(0)
    s_or_b32 s70, s70, 1
    v_mov_b32 v248, s70
    v_mov_b32 v249, s71
    v_mov_b32 v247, 0
    s_mov_b32 s96, s30
    s_and_b32 s97, s31, 0xffff
    s_mov_b32 s98, 0x100
    s_mov_b32 s99, 0x20000
    buffer_store_dwordx2 v[248:249], v247, s[96:99], 0 offen offset:128 sc1
concat_heads__linear_attn_block__ssm_conv_s5__prompt_kernel_nononce:
    v_and_b32 v10, 31, v0
    v_lshrrev_b32 v11, 5, v0
    s_lshl_b32 s64, s3, 5
    v_add_u32 v12, s64, v10
    v_lshlrev_b32 v12, 7, v12
    v_lshrrev_b32 v13, 1, v10
    v_and_b32 v13, 7, v13
    v_xor_b32 v13, v13, v11
    v_lshlrev_b32 v13, 4, v13
    v_add_u32 v4, v12, v13
    v_xor_b32 v5, 32, v4
    v_xor_b32 v6, 64, v4
    v_xor_b32 v7, 96, v4
    v_lshrrev_b32 v12, 5, v0
    v_lshlrev_b32 v12, 3, v12
    v_bfe_u32 v13, v0, 2, 2
    v_add_u32 v12, v12, v13
    v_lshlrev_b32 v12, 7, v12
    v_bfe_u32 v13, v0, 3, 1
    v_lshlrev_b32 v13, 6, v13
    v_add_u32 v12, v12, v13
    v_bfe_u32 v13, v0, 4, 1
    v_lshlrev_b32 v13, 5, v13
    v_add_u32 v12, v12, v13
    v_and_b32 v13, 3, v0
    v_lshlrev_b32 v13, 3, v13
    v_add_u32 v8, v12, v13
    v_xor_b32 v9, 64, v8
    v_add_u32 v2, 98304, v8
    v_add_u32 v3, 98304, v9
    s_mov_b32 s76, 0x3fb8aa3b
    s_mov_b32 s77, 0x3fb8aa3b
    v_cmp_gt_u32 s[74:75], 16, v10
    v_mov_b32 v16, 0
    v_mov_b32 v17, 0
    v_mov_b32 v18, 0
    v_mov_b32 v19, 0
    v_mov_b32 v20, 0
    v_mov_b32 v21, 0
    v_mov_b32 v22, 0
    v_mov_b32 v23, 0
    v_mov_b32 v24, 0
    v_mov_b32 v25, 0
    v_mov_b32 v26, 0
    v_mov_b32 v27, 0
    v_mov_b32 v28, 0
    v_mov_b32 v29, 0
    v_mov_b32 v30, 0
    v_mov_b32 v31, 0
    v_mov_b32 v32, 0
    v_mov_b32 v33, 0
    v_mov_b32 v34, 0
    v_mov_b32 v35, 0
    v_mov_b32 v36, 0
    v_mov_b32 v37, 0
    v_mov_b32 v38, 0
    v_mov_b32 v39, 0
    v_mov_b32 v40, 0
    v_mov_b32 v41, 0
    v_mov_b32 v42, 0
    v_mov_b32 v43, 0
    v_mov_b32 v44, 0
    v_mov_b32 v45, 0
    v_mov_b32 v46, 0
    v_mov_b32 v47, 0
    v_mov_b32 v48, 0
    v_mov_b32 v49, 0
    v_mov_b32 v50, 0
    v_mov_b32 v51, 0
    v_mov_b32 v52, 0
    v_mov_b32 v53, 0
    v_mov_b32 v54, 0
    v_mov_b32 v55, 0
    v_mov_b32 v56, 0
    v_mov_b32 v57, 0
    v_mov_b32 v58, 0
    v_mov_b32 v59, 0
    v_mov_b32 v60, 0
    v_mov_b32 v61, 0
    v_mov_b32 v62, 0
    v_mov_b32 v63, 0
    v_mov_b32 v64, 0
    v_mov_b32 v65, 0
    v_mov_b32 v66, 0
    v_mov_b32 v67, 0
    v_mov_b32 v68, 0
    v_mov_b32 v69, 0
    v_mov_b32 v70, 0
    v_mov_b32 v71, 0
    v_mov_b32 v72, 0
    v_mov_b32 v73, 0
    v_mov_b32 v74, 0
    v_mov_b32 v75, 0
    v_mov_b32 v76, 0
    v_mov_b32 v77, 0
    v_mov_b32 v78, 0
    v_mov_b32 v79, 0
    v_and_b32 v12, 15, v10
    v_lshlrev_b32 v13, 4, v11
    v_add_u32 v12, v12, v13
    v_lshlrev_b32 v12, 5, v12
    v_lshrrev_b32 v13, 4, v10
    v_mul_u32_u24 v13, 1152, v13
    v_add_u32 v12, v12, v13
    s_mul_i32 s66, s3, 4608
    s_add_u32 s66, s66, 0
    v_add_u32 v12, s66, v12
    v_lshlrev_b32 v14, 5, v11
    v_add_u32 v14, v14, v13
    v_add_u32 v14, s66, v14
    v_add_u32 v14, 1024, v14
    s_waitcnt lgkmcnt(0)
    s_mov_b32 s48, s32
    s_and_b32 s49, s33, 0xffff
    s_mov_b32 s50, 0x10000000
    s_mov_b32 s51, 0x20000
    s_add_u32 s64, s37, 0
    s_lshl_b32 s64, s64, 10
    s_add_u32 s64, s64, 7602176
    s_lshl_b32 s65, s38, 7
    s_add_u32 s64, s64, s65
    v_mov_b32 v245, 0
    s_mov_b64 s[74:75], exec
    s_mov_b64 exec, 1
    buffer_load_dword v246, v245, s[48:51], s64 offen sc1
    s_mov_b64 exec, s[74:75]
    v_mov_b32 v252, 0
    s_lshl_b32 s64, s37, 2
    s_add_u32 s64, s64, s3
    s_lshl_b32 s64, s64, 5
    s_lshl_b32 s65, s38, 2
    s_add_u32 s64, s64, s65
    s_lshl_b32 s64, s64, 10
    buffer_load_dword v253, v252, s[48:51], s64 offen sc1
    s_mov_b32 s52, s28
    s_and_b32 s53, s29, 0xffff
    s_mov_b32 s54, 0x800000
    s_mov_b32 s55, 0x20000
    s_lshl_b32 s64, s37, 7
    s_lshl_b32 s65, s3, 5
    s_add_u32 s64, s64, s65
    s_lshl_b32 s64, s64, 12
    s_lshl_b32 s65, s38, 8
    s_add_u32 s64, s64, s65
    buffer_load_dword v253, v252, s[52:55], s64 offen sc1
    s_lshl_b32 s64, s2, 2
    s_add_u32 s64, s64, s3
    s_mul_i32 s64, s64, 12
    v_add_u32 v242, s64, v0
    v_lshlrev_b32 v242, 7, v242
    s_mov_b32 s52, s8
    s_and_b32 s53, s9, 0xffff
    s_mov_b32 s54, 0x80000
    s_mov_b32 s55, 0x20000
    s_mov_b32 s56, s20
    s_and_b32 s57, s21, 0xffff
    s_mov_b32 s58, 0x80000
    s_mov_b32 s59, 0x20000
    s_mov_b32 s60, s22
    s_and_b32 s61, s23, 0xffff
    s_mov_b32 s62, 0x80000
    s_mov_b32 s63, 0x20000
    s_mov_b64 s[74:75], exec
    s_mov_b64 exec, 0xfff
    buffer_load_dword v243, v242, s[52:55], 0 offen sc1
    v_subrev_u32 v244, 0x80000, v242
    buffer_load_dword v243, v244, s[56:59], 0 offen sc1
    v_subrev_u32 v244, 0x100000, v242
    buffer_load_dword v243, v244, s[60:63], 0 offen sc1
    s_mov_b64 exec, s[74:75]
    v_cmp_gt_u32 s[74:75], 16, v10
    s_barrier
    ds_read_b128 v[112:115], v4
    ds_read_b64_tr_b16 v[80:81], v8 offset:16384
    ds_read_b64_tr_b16 v[82:83], v8 offset:16896
    ds_read_b64_tr_b16 v[84:85], v9 offset:16384
    ds_read_b64_tr_b16 v[86:87], v9 offset:16896
    ds_read_b64_tr_b16 v[88:89], v8 offset:24576
    ds_read_b64_tr_b16 v[90:91], v8 offset:25088
    ds_read_b64_tr_b16 v[92:93], v9 offset:24576
    ds_read_b64_tr_b16 v[94:95], v9 offset:25088
    s_waitcnt lgkmcnt(6)
    v_mfma_f32_32x32x16_bf16 v[16:31], v[112:115], v[80:83], v[16:31]
    ds_read_b128 v[116:119], v5
    ds_read_b64_tr_b16 v[96:97], v8 offset:18432
    ds_read_b64_tr_b16 v[98:99], v8 offset:18944
    s_waitcnt lgkmcnt(7)
    v_mfma_f32_32x32x16_bf16 v[32:47], v[112:115], v[84:87], v[32:47]
    ds_read_b64_tr_b16 v[100:101], v9 offset:18432
    ds_read_b64_tr_b16 v[102:103], v9 offset:18944
    s_waitcnt lgkmcnt(7)
    v_mfma_f32_32x32x16_bf16 v[48:63], v[112:115], v[88:91], v[48:63]
    ds_read_b64_tr_b16 v[104:105], v8 offset:26624
    ds_read_b64_tr_b16 v[106:107], v8 offset:27136
    s_waitcnt lgkmcnt(7)
    v_mfma_f32_32x32x16_bf16 v[64:79], v[112:115], v[92:95], v[64:79]
    ds_read_b64_tr_b16 v[108:109], v9 offset:26624
    ds_read_b64_tr_b16 v[110:111], v9 offset:27136
    s_waitcnt lgkmcnt(6)
    v_mfma_f32_32x32x16_bf16 v[16:31], v[116:119], v[96:99], v[16:31]
    ds_read_b128 v[120:123], v6
    ds_read_b64_tr_b16 v[80:81], v8 offset:20480
    ds_read_b64_tr_b16 v[82:83], v8 offset:20992
    s_waitcnt lgkmcnt(7)
    v_mfma_f32_32x32x16_bf16 v[32:47], v[116:119], v[100:103], v[32:47]
    ds_read_b64_tr_b16 v[84:85], v9 offset:20480
    ds_read_b64_tr_b16 v[86:87], v9 offset:20992
    s_waitcnt lgkmcnt(7)
    v_mfma_f32_32x32x16_bf16 v[48:63], v[116:119], v[104:107], v[48:63]
    ds_read_b64_tr_b16 v[88:89], v8 offset:28672
    ds_read_b64_tr_b16 v[90:91], v8 offset:29184
    s_waitcnt lgkmcnt(7)
    v_mfma_f32_32x32x16_bf16 v[64:79], v[116:119], v[108:111], v[64:79]
    ds_read_b64_tr_b16 v[92:93], v9 offset:28672
    ds_read_b64_tr_b16 v[94:95], v9 offset:29184
    s_waitcnt lgkmcnt(6)
    v_mfma_f32_32x32x16_bf16 v[16:31], v[120:123], v[80:83], v[16:31]
    ds_read_b128 v[124:127], v7
    ds_read_b64_tr_b16 v[96:97], v8 offset:22528
    ds_read_b64_tr_b16 v[98:99], v8 offset:23040
    s_waitcnt lgkmcnt(7)
    v_mfma_f32_32x32x16_bf16 v[32:47], v[120:123], v[84:87], v[32:47]
    ds_read_b64_tr_b16 v[100:101], v9 offset:22528
    ds_read_b64_tr_b16 v[102:103], v9 offset:23040
    s_waitcnt lgkmcnt(7)
    v_mfma_f32_32x32x16_bf16 v[48:63], v[120:123], v[88:91], v[48:63]
    ds_read_b64_tr_b16 v[104:105], v8 offset:30720
    ds_read_b64_tr_b16 v[106:107], v8 offset:31232
    s_waitcnt lgkmcnt(7)
    v_mfma_f32_32x32x16_bf16 v[64:79], v[120:123], v[92:95], v[64:79]
    ds_read_b64_tr_b16 v[108:109], v9 offset:30720
    ds_read_b64_tr_b16 v[110:111], v9 offset:31232
    s_barrier
    v_add_u32 v4, 0x8000, v4
    v_add_u32 v5, 0x8000, v5
    v_add_u32 v6, 0x8000, v6
    v_add_u32 v7, 0x8000, v7
    v_add_u32 v8, 0x8000, v8
    v_add_u32 v9, 0x8000, v9
    s_waitcnt lgkmcnt(6)
    v_mfma_f32_32x32x16_bf16 v[16:31], v[124:127], v[96:99], v[16:31]
    ds_read_b128 v[128:131], v4
    ds_read_b64_tr_b16 v[80:81], v8 offset:16384
    ds_read_b64_tr_b16 v[82:83], v8 offset:16896
    s_waitcnt lgkmcnt(7)
    v_mfma_f32_32x32x16_bf16 v[32:47], v[124:127], v[100:103], v[32:47]
    ds_read_b64_tr_b16 v[84:85], v9 offset:16384
    ds_read_b64_tr_b16 v[86:87], v9 offset:16896
    s_waitcnt lgkmcnt(7)
    v_mfma_f32_32x32x16_bf16 v[48:63], v[124:127], v[104:107], v[48:63]
    ds_read_b64_tr_b16 v[88:89], v8 offset:24576
    ds_read_b64_tr_b16 v[90:91], v8 offset:25088
    s_waitcnt lgkmcnt(7)
    v_mfma_f32_32x32x16_bf16 v[64:79], v[124:127], v[108:111], v[64:79]
    ds_read_b64_tr_b16 v[92:93], v9 offset:24576
    ds_read_b64_tr_b16 v[94:95], v9 offset:25088
    s_waitcnt lgkmcnt(6)
    v_mfma_f32_32x32x16_bf16 v[16:31], v[128:131], v[80:83], v[16:31]
    ds_read_b128 v[132:135], v5
    ds_read_b64_tr_b16 v[96:97], v8 offset:18432
    ds_read_b64_tr_b16 v[98:99], v8 offset:18944
    s_waitcnt lgkmcnt(7)
    v_mfma_f32_32x32x16_bf16 v[32:47], v[128:131], v[84:87], v[32:47]
    ds_read_b64_tr_b16 v[100:101], v9 offset:18432
    ds_read_b64_tr_b16 v[102:103], v9 offset:18944
    s_waitcnt lgkmcnt(7)
    v_mfma_f32_32x32x16_bf16 v[48:63], v[128:131], v[88:91], v[48:63]
    ds_read_b64_tr_b16 v[104:105], v8 offset:26624
    ds_read_b64_tr_b16 v[106:107], v8 offset:27136
    s_waitcnt lgkmcnt(7)
    v_mfma_f32_32x32x16_bf16 v[64:79], v[128:131], v[92:95], v[64:79]
    ds_read_b64_tr_b16 v[108:109], v9 offset:26624
    ds_read_b64_tr_b16 v[110:111], v9 offset:27136
    s_waitcnt lgkmcnt(6)
    v_mfma_f32_32x32x16_bf16 v[16:31], v[132:135], v[96:99], v[16:31]
    ds_read_b128 v[136:139], v6
    ds_read_b64_tr_b16 v[80:81], v8 offset:20480
    ds_read_b64_tr_b16 v[82:83], v8 offset:20992
    s_waitcnt lgkmcnt(7)
    v_mfma_f32_32x32x16_bf16 v[32:47], v[132:135], v[100:103], v[32:47]
    ds_read_b64_tr_b16 v[84:85], v9 offset:20480
    ds_read_b64_tr_b16 v[86:87], v9 offset:20992
    s_waitcnt lgkmcnt(7)
    v_mfma_f32_32x32x16_bf16 v[48:63], v[132:135], v[104:107], v[48:63]
    ds_read_b64_tr_b16 v[88:89], v8 offset:28672
    ds_read_b64_tr_b16 v[90:91], v8 offset:29184
    s_waitcnt lgkmcnt(7)
    v_mfma_f32_32x32x16_bf16 v[64:79], v[132:135], v[108:111], v[64:79]
    ds_read_b64_tr_b16 v[92:93], v9 offset:28672
    ds_read_b64_tr_b16 v[94:95], v9 offset:29184
    s_waitcnt lgkmcnt(6)
    v_mfma_f32_32x32x16_bf16 v[16:31], v[136:139], v[80:83], v[16:31]
    ds_read_b128 v[140:143], v7
    ds_read_b64_tr_b16 v[96:97], v8 offset:22528
    ds_read_b64_tr_b16 v[98:99], v8 offset:23040
    s_waitcnt lgkmcnt(7)
    v_mfma_f32_32x32x16_bf16 v[32:47], v[136:139], v[84:87], v[32:47]
    ds_read_b64_tr_b16 v[100:101], v9 offset:22528
    ds_read_b64_tr_b16 v[102:103], v9 offset:23040
    s_waitcnt lgkmcnt(7)
    v_mfma_f32_32x32x16_bf16 v[48:63], v[136:139], v[88:91], v[48:63]
    ds_read_b64_tr_b16 v[104:105], v8 offset:30720
    ds_read_b64_tr_b16 v[106:107], v8 offset:31232
    s_waitcnt lgkmcnt(7)
    v_mfma_f32_32x32x16_bf16 v[64:79], v[136:139], v[92:95], v[64:79]
    ds_read_b64_tr_b16 v[108:109], v9 offset:30720
    ds_read_b64_tr_b16 v[110:111], v9 offset:31232
    s_barrier
    v_add_u32 v4, 0x8000, v4
    v_add_u32 v5, 0x8000, v5
    v_add_u32 v6, 0x8000, v6
    v_add_u32 v7, 0x8000, v7
    v_add_u32 v8, 0x8000, v8
    v_add_u32 v9, 0x8000, v9
    s_waitcnt lgkmcnt(6)
    v_mfma_f32_32x32x16_bf16 v[16:31], v[140:143], v[96:99], v[16:31]
    ds_read_b128 v[144:147], v4
    ds_read_b64_tr_b16 v[80:81], v8 offset:16384
    ds_read_b64_tr_b16 v[82:83], v8 offset:16896
    s_waitcnt lgkmcnt(7)
    v_mfma_f32_32x32x16_bf16 v[32:47], v[140:143], v[100:103], v[32:47]
    ds_read_b64_tr_b16 v[84:85], v9 offset:16384
    ds_read_b64_tr_b16 v[86:87], v9 offset:16896
    s_waitcnt lgkmcnt(7)
    v_mfma_f32_32x32x16_bf16 v[48:63], v[140:143], v[104:107], v[48:63]
    ds_read_b64_tr_b16 v[88:89], v8 offset:24576
    ds_read_b64_tr_b16 v[90:91], v8 offset:25088
    s_waitcnt lgkmcnt(7)
    v_mfma_f32_32x32x16_bf16 v[64:79], v[140:143], v[108:111], v[64:79]
    ds_read_b64_tr_b16 v[92:93], v9 offset:24576
    ds_read_b64_tr_b16 v[94:95], v9 offset:25088
    s_waitcnt lgkmcnt(6)
    v_mfma_f32_32x32x16_bf16 v[16:31], v[144:147], v[80:83], v[16:31]
    ds_read_b128 v[148:151], v5
    ds_read_b64_tr_b16 v[96:97], v8 offset:18432
    ds_read_b64_tr_b16 v[98:99], v8 offset:18944
    s_waitcnt lgkmcnt(7)
    v_mfma_f32_32x32x16_bf16 v[32:47], v[144:147], v[84:87], v[32:47]
    ds_read_b64_tr_b16 v[100:101], v9 offset:18432
    ds_read_b64_tr_b16 v[102:103], v9 offset:18944
    s_waitcnt lgkmcnt(7)
    v_mfma_f32_32x32x16_bf16 v[48:63], v[144:147], v[88:91], v[48:63]
    ds_read_b64_tr_b16 v[104:105], v8 offset:26624
    ds_read_b64_tr_b16 v[106:107], v8 offset:27136
    s_waitcnt lgkmcnt(7)
    v_mfma_f32_32x32x16_bf16 v[64:79], v[144:147], v[92:95], v[64:79]
    ds_read_b64_tr_b16 v[108:109], v9 offset:26624
    ds_read_b64_tr_b16 v[110:111], v9 offset:27136
    s_waitcnt lgkmcnt(6)
    v_mfma_f32_32x32x16_bf16 v[16:31], v[148:151], v[96:99], v[16:31]
    ds_read_b128 v[152:155], v6
    ds_read_b64_tr_b16 v[80:81], v8 offset:20480
    ds_read_b64_tr_b16 v[82:83], v8 offset:20992
    s_waitcnt lgkmcnt(7)
    v_mfma_f32_32x32x16_bf16 v[32:47], v[148:151], v[100:103], v[32:47]
    ds_read_b64_tr_b16 v[84:85], v9 offset:20480
    ds_read_b64_tr_b16 v[86:87], v9 offset:20992
    s_waitcnt lgkmcnt(7)
    v_mfma_f32_32x32x16_bf16 v[48:63], v[148:151], v[104:107], v[48:63]
    ds_read_b64_tr_b16 v[88:89], v8 offset:28672
    ds_read_b64_tr_b16 v[90:91], v8 offset:29184
    s_waitcnt lgkmcnt(7)
    v_mfma_f32_32x32x16_bf16 v[64:79], v[148:151], v[108:111], v[64:79]
    ds_read_b64_tr_b16 v[92:93], v9 offset:28672
    ds_read_b64_tr_b16 v[94:95], v9 offset:29184
    s_waitcnt lgkmcnt(6)
    v_mfma_f32_32x32x16_bf16 v[16:31], v[152:155], v[80:83], v[16:31]
    ds_read_b128 v[156:159], v7
    ds_read_b64_tr_b16 v[96:97], v8 offset:22528
    ds_read_b64_tr_b16 v[98:99], v8 offset:23040
    s_waitcnt lgkmcnt(7)
    v_mfma_f32_32x32x16_bf16 v[32:47], v[152:155], v[84:87], v[32:47]
    ds_read_b64_tr_b16 v[100:101], v9 offset:22528
    ds_read_b64_tr_b16 v[102:103], v9 offset:23040
    s_waitcnt lgkmcnt(7)
    v_mfma_f32_32x32x16_bf16 v[48:63], v[152:155], v[88:91], v[48:63]
    ds_read_b64_tr_b16 v[104:105], v8 offset:30720
    ds_read_b64_tr_b16 v[106:107], v8 offset:31232
    s_waitcnt lgkmcnt(7)
    v_mfma_f32_32x32x16_bf16 v[64:79], v[152:155], v[92:95], v[64:79]
    ds_read_b64_tr_b16 v[108:109], v9 offset:30720
    ds_read_b64_tr_b16 v[110:111], v9 offset:31232
    s_barrier
    v_add_u32 v4, 0x8000, v4
    v_add_u32 v5, 0x8000, v5
    v_add_u32 v6, 0x8000, v6
    v_add_u32 v7, 0x8000, v7
    v_add_u32 v8, 0x8000, v8
    v_add_u32 v9, 0x8000, v9
    s_waitcnt lgkmcnt(6)
    v_mfma_f32_32x32x16_bf16 v[16:31], v[156:159], v[96:99], v[16:31]
    ds_read_b128 v[160:163], v4
    ds_read_b64_tr_b16 v[80:81], v8 offset:16384
    ds_read_b64_tr_b16 v[82:83], v8 offset:16896
    s_waitcnt lgkmcnt(7)
    v_mfma_f32_32x32x16_bf16 v[32:47], v[156:159], v[100:103], v[32:47]
    ds_read_b64_tr_b16 v[84:85], v9 offset:16384
    ds_read_b64_tr_b16 v[86:87], v9 offset:16896
    s_waitcnt lgkmcnt(7)
    v_mfma_f32_32x32x16_bf16 v[48:63], v[156:159], v[104:107], v[48:63]
    ds_read_b64_tr_b16 v[88:89], v8 offset:24576
    ds_read_b64_tr_b16 v[90:91], v8 offset:25088
    s_waitcnt lgkmcnt(7)
    v_mfma_f32_32x32x16_bf16 v[64:79], v[156:159], v[108:111], v[64:79]
    ds_read_b64_tr_b16 v[92:93], v9 offset:24576
    ds_read_b64_tr_b16 v[94:95], v9 offset:25088
    s_waitcnt lgkmcnt(6)
    v_mfma_f32_32x32x16_bf16 v[16:31], v[160:163], v[80:83], v[16:31]
    ds_read_b128 v[164:167], v5
    ds_read_b64_tr_b16 v[96:97], v8 offset:18432
    ds_read_b64_tr_b16 v[98:99], v8 offset:18944
    s_waitcnt lgkmcnt(7)
    v_mfma_f32_32x32x16_bf16 v[32:47], v[160:163], v[84:87], v[32:47]
    ds_read_b64_tr_b16 v[100:101], v9 offset:18432
    ds_read_b64_tr_b16 v[102:103], v9 offset:18944
    s_waitcnt lgkmcnt(7)
    v_mfma_f32_32x32x16_bf16 v[48:63], v[160:163], v[88:91], v[48:63]
    ds_read_b64_tr_b16 v[104:105], v8 offset:26624
    ds_read_b64_tr_b16 v[106:107], v8 offset:27136
    s_waitcnt lgkmcnt(7)
    v_mfma_f32_32x32x16_bf16 v[64:79], v[160:163], v[92:95], v[64:79]
    ds_read_b64_tr_b16 v[108:109], v9 offset:26624
    ds_read_b64_tr_b16 v[110:111], v9 offset:27136
    s_waitcnt lgkmcnt(6)
    v_mfma_f32_32x32x16_bf16 v[16:31], v[164:167], v[96:99], v[16:31]
    ds_read_b128 v[168:171], v6
    ds_read_b64_tr_b16 v[80:81], v8 offset:20480
    ds_read_b64_tr_b16 v[82:83], v8 offset:20992
    s_waitcnt lgkmcnt(7)
    v_mfma_f32_32x32x16_bf16 v[32:47], v[164:167], v[100:103], v[32:47]
    ds_read_b64_tr_b16 v[84:85], v9 offset:20480
    ds_read_b64_tr_b16 v[86:87], v9 offset:20992
    s_waitcnt lgkmcnt(7)
    v_mfma_f32_32x32x16_bf16 v[48:63], v[164:167], v[104:107], v[48:63]
    ds_read_b64_tr_b16 v[88:89], v8 offset:28672
    ds_read_b64_tr_b16 v[90:91], v8 offset:29184
    s_waitcnt lgkmcnt(7)
    v_mfma_f32_32x32x16_bf16 v[64:79], v[164:167], v[108:111], v[64:79]
    ds_read_b64_tr_b16 v[92:93], v9 offset:28672
    ds_read_b64_tr_b16 v[94:95], v9 offset:29184
    s_waitcnt lgkmcnt(6)
    v_mfma_f32_32x32x16_bf16 v[16:31], v[168:171], v[80:83], v[16:31]
    ds_read_b128 v[172:175], v7
    ds_read_b64_tr_b16 v[96:97], v8 offset:22528
    ds_read_b64_tr_b16 v[98:99], v8 offset:23040
    s_waitcnt lgkmcnt(7)
    v_mfma_f32_32x32x16_bf16 v[32:47], v[168:171], v[84:87], v[32:47]
    ds_read_b64_tr_b16 v[100:101], v9 offset:22528
    ds_read_b64_tr_b16 v[102:103], v9 offset:23040
    s_waitcnt lgkmcnt(7)
    v_mfma_f32_32x32x16_bf16 v[48:63], v[168:171], v[88:91], v[48:63]
    ds_read_b64_tr_b16 v[104:105], v8 offset:30720
    ds_read_b64_tr_b16 v[106:107], v8 offset:31232
    s_waitcnt lgkmcnt(7)
    v_mfma_f32_32x32x16_bf16 v[64:79], v[168:171], v[92:95], v[64:79]
    ds_read_b64_tr_b16 v[108:109], v9 offset:30720
    ds_read_b64_tr_b16 v[110:111], v9 offset:31232
    s_barrier
    v_add_u32 v4, 0x8000, v4
    v_add_u32 v5, 0x8000, v5
    v_add_u32 v6, 0x8000, v6
    v_add_u32 v7, 0x8000, v7
    v_add_u32 v8, 0x8000, v8
    v_add_u32 v9, 0x8000, v9
    s_waitcnt lgkmcnt(6)
    v_mfma_f32_32x32x16_bf16 v[16:31], v[172:175], v[96:99], v[16:31]
    ds_read_b128 v[176:179], v4
    ds_read_b64_tr_b16 v[80:81], v8 offset:16384
    ds_read_b64_tr_b16 v[82:83], v8 offset:16896
    s_waitcnt lgkmcnt(7)
    v_mfma_f32_32x32x16_bf16 v[32:47], v[172:175], v[100:103], v[32:47]
    ds_read_b64_tr_b16 v[84:85], v9 offset:16384
    ds_read_b64_tr_b16 v[86:87], v9 offset:16896
    s_waitcnt lgkmcnt(7)
    v_mfma_f32_32x32x16_bf16 v[48:63], v[172:175], v[104:107], v[48:63]
    ds_read_b64_tr_b16 v[88:89], v8 offset:24576
    ds_read_b64_tr_b16 v[90:91], v8 offset:25088
    s_waitcnt lgkmcnt(7)
    v_mfma_f32_32x32x16_bf16 v[64:79], v[172:175], v[108:111], v[64:79]
    ds_read_b64_tr_b16 v[92:93], v9 offset:24576
    ds_read_b64_tr_b16 v[94:95], v9 offset:25088
    s_waitcnt lgkmcnt(6)
    v_mfma_f32_32x32x16_bf16 v[16:31], v[176:179], v[80:83], v[16:31]
    ds_read_b128 v[180:183], v5
    ds_read_b64_tr_b16 v[96:97], v8 offset:18432
    ds_read_b64_tr_b16 v[98:99], v8 offset:18944
    s_waitcnt lgkmcnt(7)
    v_mfma_f32_32x32x16_bf16 v[32:47], v[176:179], v[84:87], v[32:47]
    ds_read_b64_tr_b16 v[100:101], v9 offset:18432
    ds_read_b64_tr_b16 v[102:103], v9 offset:18944
    s_waitcnt lgkmcnt(7)
    v_mfma_f32_32x32x16_bf16 v[48:63], v[176:179], v[88:91], v[48:63]
    ds_read_b64_tr_b16 v[104:105], v8 offset:26624
    ds_read_b64_tr_b16 v[106:107], v8 offset:27136
    s_waitcnt lgkmcnt(7)
    v_mfma_f32_32x32x16_bf16 v[64:79], v[176:179], v[92:95], v[64:79]
    ds_read_b64_tr_b16 v[108:109], v9 offset:26624
    ds_read_b64_tr_b16 v[110:111], v9 offset:27136
    s_waitcnt lgkmcnt(6)
    v_mfma_f32_32x32x16_bf16 v[16:31], v[180:183], v[96:99], v[16:31]
    ds_read_b128 v[184:187], v6
    ds_read_b64_tr_b16 v[80:81], v8 offset:20480
    ds_read_b64_tr_b16 v[82:83], v8 offset:20992
    s_waitcnt lgkmcnt(7)
    v_mfma_f32_32x32x16_bf16 v[32:47], v[180:183], v[100:103], v[32:47]
    ds_read_b64_tr_b16 v[84:85], v9 offset:20480
    ds_read_b64_tr_b16 v[86:87], v9 offset:20992
    s_waitcnt lgkmcnt(7)
    v_mfma_f32_32x32x16_bf16 v[48:63], v[180:183], v[104:107], v[48:63]
    ds_read_b64_tr_b16 v[88:89], v8 offset:28672
    ds_read_b64_tr_b16 v[90:91], v8 offset:29184
    s_waitcnt lgkmcnt(7)
    v_mfma_f32_32x32x16_bf16 v[64:79], v[180:183], v[108:111], v[64:79]
    ds_read_b64_tr_b16 v[92:93], v9 offset:28672
    ds_read_b64_tr_b16 v[94:95], v9 offset:29184
    s_waitcnt lgkmcnt(6)
    v_mfma_f32_32x32x16_bf16 v[16:31], v[184:187], v[80:83], v[16:31]
    ds_read_b128 v[188:191], v7
    ds_read_b64_tr_b16 v[96:97], v8 offset:22528
    ds_read_b64_tr_b16 v[98:99], v8 offset:23040
    s_waitcnt lgkmcnt(7)
    v_mfma_f32_32x32x16_bf16 v[32:47], v[184:187], v[84:87], v[32:47]
    ds_read_b64_tr_b16 v[100:101], v9 offset:22528
    ds_read_b64_tr_b16 v[102:103], v9 offset:23040
    s_waitcnt lgkmcnt(7)
    v_mfma_f32_32x32x16_bf16 v[48:63], v[184:187], v[88:91], v[48:63]
    ds_read_b64_tr_b16 v[104:105], v8 offset:30720
    ds_read_b64_tr_b16 v[106:107], v8 offset:31232
    s_waitcnt lgkmcnt(7)
    v_mfma_f32_32x32x16_bf16 v[64:79], v[184:187], v[92:95], v[64:79]
    ds_read_b64_tr_b16 v[108:109], v9 offset:30720
    ds_read_b64_tr_b16 v[110:111], v9 offset:31232
    s_barrier
    v_add_u32 v4, 0xfffe0000, v4
    v_add_u32 v5, 0xfffe0000, v5
    v_add_u32 v6, 0xfffe0000, v6
    v_add_u32 v7, 0xfffe0000, v7
    v_add_u32 v8, 0xfffe0000, v8
    v_add_u32 v9, 0xfffe0000, v9
    s_waitcnt lgkmcnt(6)
    v_mfma_f32_32x32x16_bf16 v[16:31], v[188:191], v[96:99], v[16:31]
    ds_read_b128 v[192:195], v4
    ds_read_b64_tr_b16 v[80:81], v8 offset:16384
    ds_read_b64_tr_b16 v[82:83], v8 offset:16896
    s_waitcnt lgkmcnt(7)
    v_mfma_f32_32x32x16_bf16 v[32:47], v[188:191], v[100:103], v[32:47]
    ds_read_b64_tr_b16 v[84:85], v9 offset:16384
    ds_read_b64_tr_b16 v[86:87], v9 offset:16896
    s_waitcnt lgkmcnt(7)
    v_mfma_f32_32x32x16_bf16 v[48:63], v[188:191], v[104:107], v[48:63]
    ds_read_b64_tr_b16 v[88:89], v8 offset:24576
    ds_read_b64_tr_b16 v[90:91], v8 offset:25088
    s_waitcnt lgkmcnt(7)
    v_mfma_f32_32x32x16_bf16 v[64:79], v[188:191], v[108:111], v[64:79]
    ds_read_b64_tr_b16 v[92:93], v9 offset:24576
    ds_read_b64_tr_b16 v[94:95], v9 offset:25088
    s_waitcnt lgkmcnt(6)
    v_mfma_f32_32x32x16_bf16 v[16:31], v[192:195], v[80:83], v[16:31]
    ds_read_b128 v[196:199], v5
    ds_read_b64_tr_b16 v[96:97], v8 offset:18432
    ds_read_b64_tr_b16 v[98:99], v8 offset:18944
    s_waitcnt lgkmcnt(7)
    v_mfma_f32_32x32x16_bf16 v[32:47], v[192:195], v[84:87], v[32:47]
    ds_read_b64_tr_b16 v[100:101], v9 offset:18432
    ds_read_b64_tr_b16 v[102:103], v9 offset:18944
    s_waitcnt lgkmcnt(7)
    v_mfma_f32_32x32x16_bf16 v[48:63], v[192:195], v[88:91], v[48:63]
    ds_read_b64_tr_b16 v[104:105], v8 offset:26624
    ds_read_b64_tr_b16 v[106:107], v8 offset:27136
    s_waitcnt lgkmcnt(7)
    v_mfma_f32_32x32x16_bf16 v[64:79], v[192:195], v[92:95], v[64:79]
    ds_read_b64_tr_b16 v[108:109], v9 offset:26624
    ds_read_b64_tr_b16 v[110:111], v9 offset:27136
    s_waitcnt lgkmcnt(6)
    v_mfma_f32_32x32x16_bf16 v[16:31], v[196:199], v[96:99], v[16:31]
    ds_read_b128 v[200:203], v6
    ds_read_b64_tr_b16 v[80:81], v8 offset:20480
    ds_read_b64_tr_b16 v[82:83], v8 offset:20992
    s_waitcnt lgkmcnt(7)
    v_mfma_f32_32x32x16_bf16 v[32:47], v[196:199], v[100:103], v[32:47]
    ds_read_b64_tr_b16 v[84:85], v9 offset:20480
    ds_read_b64_tr_b16 v[86:87], v9 offset:20992
    s_waitcnt lgkmcnt(7)
    v_mfma_f32_32x32x16_bf16 v[48:63], v[196:199], v[104:107], v[48:63]
    ds_read_b64_tr_b16 v[88:89], v8 offset:28672
    ds_read_b64_tr_b16 v[90:91], v8 offset:29184
    s_waitcnt lgkmcnt(7)
    v_mfma_f32_32x32x16_bf16 v[64:79], v[196:199], v[108:111], v[64:79]
    ds_read_b64_tr_b16 v[92:93], v9 offset:28672
    ds_read_b64_tr_b16 v[94:95], v9 offset:29184
    s_waitcnt lgkmcnt(6)
    v_mfma_f32_32x32x16_bf16 v[16:31], v[200:203], v[80:83], v[16:31]
    ds_read_b128 v[204:207], v7
    ds_read_b64_tr_b16 v[96:97], v8 offset:22528
    ds_read_b64_tr_b16 v[98:99], v8 offset:23040
    s_waitcnt lgkmcnt(7)
    v_mfma_f32_32x32x16_bf16 v[32:47], v[200:203], v[84:87], v[32:47]
    ds_read_b64_tr_b16 v[100:101], v9 offset:22528
    ds_read_b64_tr_b16 v[102:103], v9 offset:23040
    s_waitcnt lgkmcnt(7)
    v_mfma_f32_32x32x16_bf16 v[48:63], v[200:203], v[88:91], v[48:63]
    ds_read_b64_tr_b16 v[104:105], v8 offset:30720
    ds_read_b64_tr_b16 v[106:107], v8 offset:31232
    s_waitcnt lgkmcnt(7)
    v_mfma_f32_32x32x16_bf16 v[64:79], v[200:203], v[92:95], v[64:79]
    ds_read_b64_tr_b16 v[108:109], v9 offset:30720
    ds_read_b64_tr_b16 v[110:111], v9 offset:31232
    s_barrier
    v_add_u32 v4, 0x8000, v4
    v_add_u32 v5, 0x8000, v5
    v_add_u32 v6, 0x8000, v6
    v_add_u32 v7, 0x8000, v7
    v_add_u32 v8, 0x8000, v8
    v_add_u32 v9, 0x8000, v9
    s_waitcnt lgkmcnt(6)
    v_mfma_f32_32x32x16_bf16 v[16:31], v[204:207], v[96:99], v[16:31]
    ds_read_b128 v[208:211], v4
    ds_read_b64_tr_b16 v[80:81], v8 offset:16384
    ds_read_b64_tr_b16 v[82:83], v8 offset:16896
    s_waitcnt lgkmcnt(7)
    v_mfma_f32_32x32x16_bf16 v[32:47], v[204:207], v[100:103], v[32:47]
    ds_read_b64_tr_b16 v[84:85], v9 offset:16384
    ds_read_b64_tr_b16 v[86:87], v9 offset:16896
    s_waitcnt lgkmcnt(7)
    v_mfma_f32_32x32x16_bf16 v[48:63], v[204:207], v[104:107], v[48:63]
    ds_read_b64_tr_b16 v[88:89], v8 offset:24576
    ds_read_b64_tr_b16 v[90:91], v8 offset:25088
    s_waitcnt lgkmcnt(7)
    v_mfma_f32_32x32x16_bf16 v[64:79], v[204:207], v[108:111], v[64:79]
    ds_read_b64_tr_b16 v[92:93], v9 offset:24576
    ds_read_b64_tr_b16 v[94:95], v9 offset:25088
    s_waitcnt lgkmcnt(6)
    v_mfma_f32_32x32x16_bf16 v[16:31], v[208:211], v[80:83], v[16:31]
    ds_read_b128 v[212:215], v5
    ds_read_b64_tr_b16 v[96:97], v8 offset:18432
    ds_read_b64_tr_b16 v[98:99], v8 offset:18944
    s_waitcnt lgkmcnt(7)
    v_mfma_f32_32x32x16_bf16 v[32:47], v[208:211], v[84:87], v[32:47]
    ds_read_b64_tr_b16 v[100:101], v9 offset:18432
    ds_read_b64_tr_b16 v[102:103], v9 offset:18944
    s_waitcnt lgkmcnt(7)
    v_mfma_f32_32x32x16_bf16 v[48:63], v[208:211], v[88:91], v[48:63]
    ds_read_b64_tr_b16 v[104:105], v8 offset:26624
    ds_read_b64_tr_b16 v[106:107], v8 offset:27136
    s_waitcnt lgkmcnt(7)
    v_mfma_f32_32x32x16_bf16 v[64:79], v[208:211], v[92:95], v[64:79]
    ds_read_b64_tr_b16 v[108:109], v9 offset:26624
    ds_read_b64_tr_b16 v[110:111], v9 offset:27136
    s_waitcnt lgkmcnt(6)
    v_mfma_f32_32x32x16_bf16 v[16:31], v[212:215], v[96:99], v[16:31]
    ds_read_b128 v[216:219], v6
    ds_read_b64_tr_b16 v[80:81], v8 offset:20480
    ds_read_b64_tr_b16 v[82:83], v8 offset:20992
    s_waitcnt lgkmcnt(7)
    v_mfma_f32_32x32x16_bf16 v[32:47], v[212:215], v[100:103], v[32:47]
    ds_read_b64_tr_b16 v[84:85], v9 offset:20480
    ds_read_b64_tr_b16 v[86:87], v9 offset:20992
    s_waitcnt lgkmcnt(7)
    v_mfma_f32_32x32x16_bf16 v[48:63], v[212:215], v[104:107], v[48:63]
    ds_read_b64_tr_b16 v[88:89], v8 offset:28672
    ds_read_b64_tr_b16 v[90:91], v8 offset:29184
    s_waitcnt lgkmcnt(7)
    v_mfma_f32_32x32x16_bf16 v[64:79], v[212:215], v[108:111], v[64:79]
    ds_read_b64_tr_b16 v[92:93], v9 offset:28672
    ds_read_b64_tr_b16 v[94:95], v9 offset:29184
    s_waitcnt lgkmcnt(6)
    v_mfma_f32_32x32x16_bf16 v[16:31], v[216:219], v[80:83], v[16:31]
    ds_read_b128 v[220:223], v7
    ds_read_b64_tr_b16 v[96:97], v8 offset:22528
    ds_read_b64_tr_b16 v[98:99], v8 offset:23040
    s_waitcnt lgkmcnt(7)
    v_mfma_f32_32x32x16_bf16 v[32:47], v[216:219], v[84:87], v[32:47]
    ds_read_b64_tr_b16 v[100:101], v9 offset:22528
    ds_read_b64_tr_b16 v[102:103], v9 offset:23040
    s_waitcnt lgkmcnt(7)
    v_mfma_f32_32x32x16_bf16 v[48:63], v[216:219], v[88:91], v[48:63]
    ds_read_b64_tr_b16 v[104:105], v8 offset:30720
    ds_read_b64_tr_b16 v[106:107], v8 offset:31232
    s_waitcnt lgkmcnt(7)
    v_mfma_f32_32x32x16_bf16 v[64:79], v[216:219], v[92:95], v[64:79]
    ds_read_b64_tr_b16 v[108:109], v9 offset:30720
    ds_read_b64_tr_b16 v[110:111], v9 offset:31232
    s_barrier
    v_add_u32 v4, 0x8000, v4
    v_add_u32 v5, 0x8000, v5
    v_add_u32 v6, 0x8000, v6
    v_add_u32 v7, 0x8000, v7
    v_add_u32 v8, 0x8000, v8
    v_add_u32 v9, 0x8000, v9
    s_waitcnt lgkmcnt(6)
    v_mfma_f32_32x32x16_bf16 v[16:31], v[220:223], v[96:99], v[16:31]
    ds_read_b128 v[224:227], v4
    ds_read_b64_tr_b16 v[80:81], v8 offset:16384
    ds_read_b64_tr_b16 v[82:83], v8 offset:16896
    s_waitcnt lgkmcnt(7)
    v_mfma_f32_32x32x16_bf16 v[32:47], v[220:223], v[100:103], v[32:47]
    ds_read_b64_tr_b16 v[84:85], v9 offset:16384
    ds_read_b64_tr_b16 v[86:87], v9 offset:16896
    s_waitcnt lgkmcnt(7)
    v_mfma_f32_32x32x16_bf16 v[48:63], v[220:223], v[104:107], v[48:63]
    ds_read_b64_tr_b16 v[88:89], v8 offset:24576
    ds_read_b64_tr_b16 v[90:91], v8 offset:25088
    s_waitcnt lgkmcnt(7)
    v_mfma_f32_32x32x16_bf16 v[64:79], v[220:223], v[108:111], v[64:79]
    ds_read_b64_tr_b16 v[92:93], v9 offset:24576
    ds_read_b64_tr_b16 v[94:95], v9 offset:25088
    s_waitcnt lgkmcnt(6)
    v_mfma_f32_32x32x16_bf16 v[16:31], v[224:227], v[80:83], v[16:31]
    ds_read_b128 v[228:231], v5
    ds_read_b64_tr_b16 v[96:97], v8 offset:18432
    ds_read_b64_tr_b16 v[98:99], v8 offset:18944
    s_waitcnt lgkmcnt(7)
    v_mfma_f32_32x32x16_bf16 v[32:47], v[224:227], v[84:87], v[32:47]
    ds_read_b64_tr_b16 v[100:101], v9 offset:18432
    ds_read_b64_tr_b16 v[102:103], v9 offset:18944
    s_waitcnt lgkmcnt(7)
    v_mfma_f32_32x32x16_bf16 v[48:63], v[224:227], v[88:91], v[48:63]
    ds_read_b64_tr_b16 v[104:105], v8 offset:26624
    ds_read_b64_tr_b16 v[106:107], v8 offset:27136
    s_waitcnt lgkmcnt(7)
    v_mfma_f32_32x32x16_bf16 v[64:79], v[224:227], v[92:95], v[64:79]
    ds_read_b64_tr_b16 v[108:109], v9 offset:26624
    ds_read_b64_tr_b16 v[110:111], v9 offset:27136
    s_waitcnt lgkmcnt(6)
    v_mfma_f32_32x32x16_bf16 v[16:31], v[228:231], v[96:99], v[16:31]
    ds_read_b128 v[232:235], v6
    ds_read_b64_tr_b16 v[80:81], v8 offset:20480
    ds_read_b64_tr_b16 v[82:83], v8 offset:20992
    s_waitcnt lgkmcnt(7)
    v_mfma_f32_32x32x16_bf16 v[32:47], v[228:231], v[100:103], v[32:47]
    ds_read_b64_tr_b16 v[84:85], v9 offset:20480
    ds_read_b64_tr_b16 v[86:87], v9 offset:20992
    s_waitcnt lgkmcnt(7)
    v_mfma_f32_32x32x16_bf16 v[48:63], v[228:231], v[104:107], v[48:63]
    ds_read_b64_tr_b16 v[88:89], v8 offset:28672
    ds_read_b64_tr_b16 v[90:91], v8 offset:29184
    s_waitcnt lgkmcnt(7)
    v_mfma_f32_32x32x16_bf16 v[64:79], v[228:231], v[108:111], v[64:79]
    ds_read_b64_tr_b16 v[92:93], v9 offset:28672
    ds_read_b64_tr_b16 v[94:95], v9 offset:29184
    s_waitcnt lgkmcnt(6)
    v_mfma_f32_32x32x16_bf16 v[16:31], v[232:235], v[80:83], v[16:31]
    ds_read_b128 v[236:239], v7
    ds_read_b64_tr_b16 v[96:97], v8 offset:22528
    ds_read_b64_tr_b16 v[98:99], v8 offset:23040
    s_waitcnt lgkmcnt(7)
    v_mfma_f32_32x32x16_bf16 v[32:47], v[232:235], v[84:87], v[32:47]
    ds_read_b64_tr_b16 v[100:101], v9 offset:22528
    ds_read_b64_tr_b16 v[102:103], v9 offset:23040
    s_waitcnt lgkmcnt(7)
    v_mfma_f32_32x32x16_bf16 v[48:63], v[232:235], v[88:91], v[48:63]
    ds_read_b64_tr_b16 v[104:105], v8 offset:30720
    ds_read_b64_tr_b16 v[106:107], v8 offset:31232
    s_waitcnt lgkmcnt(7)
    v_mfma_f32_32x32x16_bf16 v[64:79], v[232:235], v[92:95], v[64:79]
    ds_read_b64_tr_b16 v[108:109], v9 offset:30720
    ds_read_b64_tr_b16 v[110:111], v9 offset:31232
    s_waitcnt lgkmcnt(6)
    v_mfma_f32_32x32x16_bf16 v[16:31], v[236:239], v[96:99], v[16:31]
    s_waitcnt lgkmcnt(4)
    v_mfma_f32_32x32x16_bf16 v[32:47], v[236:239], v[100:103], v[32:47]
    s_waitcnt lgkmcnt(2)
    v_mfma_f32_32x32x16_bf16 v[48:63], v[236:239], v[104:107], v[48:63]
    s_waitcnt lgkmcnt(0)
    v_mfma_f32_32x32x16_bf16 v[64:79], v[236:239], v[108:111], v[64:79]
    s_waitcnt vmcnt(0)
    s_mov_b32 s64, 0x358637bd
    s_mov_b32 s65, 0x358637bd
    v_mov_b32 v248, 0x3f803f80
    v_mov_b32 v249, 0x3f803f80
    v_mov_b32 v250, 0x3f803f80
    v_mov_b32 v251, 0x3f803f80
    s_nop 3
    v_pk_mul_f32 v[240:241], v[16:17], s[76:77]
    v_pk_mul_f32 v[242:243], v[18:19], s[76:77]
    v_pk_mul_f32 v[244:245], v[20:21], s[76:77]
    v_pk_mul_f32 v[246:247], v[22:23], s[76:77]
    v_exp_f32_e64 v240, v240 clamp
    v_exp_f32_e64 v241, v241 clamp
    v_exp_f32_e64 v242, v242 clamp
    v_exp_f32_e64 v243, v243 clamp
    v_exp_f32_e64 v244, v244 clamp
    v_exp_f32_e64 v245, v245 clamp
    v_exp_f32_e64 v246, v246 clamp
    v_exp_f32_e64 v247, v247 clamp
    v_max_f32 v16, 0, v16
    v_max_f32 v17, 0, v17
    v_max_f32 v18, 0, v18
    v_max_f32 v19, 0, v19
    v_max_f32 v20, 0, v20
    v_max_f32 v21, 0, v21
    v_max_f32 v22, 0, v22
    v_max_f32 v23, 0, v23
    v_pk_add_f32 v[16:17], v[16:17], v[240:241]
    v_pk_add_f32 v[18:19], v[18:19], v[242:243]
    v_pk_add_f32 v[20:21], v[20:21], v[244:245]
    v_pk_add_f32 v[22:23], v[22:23], v[246:247]
    v_pk_add_f32 v[16:17], v[16:17], s[64:65]
    v_pk_add_f32 v[18:19], v[18:19], s[64:65]
    v_pk_add_f32 v[20:21], v[20:21], s[64:65]
    v_pk_add_f32 v[22:23], v[22:23], s[64:65]
    v_cvt_pk_bf16_f32 v80, v16, v17
    v_cvt_pk_bf16_f32 v81, v18, v19
    v_cvt_pk_bf16_f32 v82, v20, v21
    v_cvt_pk_bf16_f32 v83, v22, v23
    v_pk_mul_f32 v[240:241], v[24:25], s[76:77]
    v_pk_mul_f32 v[242:243], v[26:27], s[76:77]
    v_pk_mul_f32 v[244:245], v[28:29], s[76:77]
    v_pk_mul_f32 v[246:247], v[30:31], s[76:77]
    v_exp_f32_e64 v240, v240 clamp
    v_exp_f32_e64 v241, v241 clamp
    v_exp_f32_e64 v242, v242 clamp
    v_exp_f32_e64 v243, v243 clamp
    v_exp_f32_e64 v244, v244 clamp
    v_exp_f32_e64 v245, v245 clamp
    v_exp_f32_e64 v246, v246 clamp
    v_exp_f32_e64 v247, v247 clamp
    v_max_f32 v24, 0, v24
    v_max_f32 v25, 0, v25
    v_max_f32 v26, 0, v26
    v_max_f32 v27, 0, v27
    v_max_f32 v28, 0, v28
    v_max_f32 v29, 0, v29
    v_max_f32 v30, 0, v30
    v_max_f32 v31, 0, v31
    v_pk_add_f32 v[24:25], v[24:25], v[240:241]
    v_pk_add_f32 v[26:27], v[26:27], v[242:243]
    v_pk_add_f32 v[28:29], v[28:29], v[244:245]
    v_pk_add_f32 v[30:31], v[30:31], v[246:247]
    v_pk_add_f32 v[24:25], v[24:25], s[64:65]
    v_pk_add_f32 v[26:27], v[26:27], s[64:65]
    v_pk_add_f32 v[28:29], v[28:29], s[64:65]
    v_pk_add_f32 v[30:31], v[30:31], s[64:65]
    v_cvt_pk_bf16_f32 v84, v24, v25
    v_cvt_pk_bf16_f32 v85, v26, v27
    v_cvt_pk_bf16_f32 v86, v28, v29
    v_cvt_pk_bf16_f32 v87, v30, v31
    v_cvt_pk_bf16_f32 v96, v48, v49
    v_cvt_pk_bf16_f32 v97, v50, v51
    v_cvt_pk_bf16_f32 v98, v52, v53
    v_cvt_pk_bf16_f32 v99, v54, v55
    v_cvt_pk_bf16_f32 v100, v56, v57
    v_cvt_pk_bf16_f32 v101, v58, v59
    v_cvt_pk_bf16_f32 v102, v60, v61
    v_cvt_pk_bf16_f32 v103, v62, v63
    s_nop 1
    v_mfma_f32_32x32x16_bf16 v[16:31], v[80:83], v[96:99], 0
    v_mfma_f32_32x32x16_bf16 v[48:63], v[80:83], v[248:251], 0
    v_mfma_f32_32x32x16_bf16 v[16:31], v[84:87], v[100:103], v[16:31]
    v_mfma_f32_32x32x16_bf16 v[48:63], v[84:87], v[248:251], v[48:63]
    v_pk_mul_f32 v[240:241], v[32:33], s[76:77]
    v_pk_mul_f32 v[242:243], v[34:35], s[76:77]
    v_pk_mul_f32 v[244:245], v[36:37], s[76:77]
    v_pk_mul_f32 v[246:247], v[38:39], s[76:77]
    v_exp_f32_e64 v240, v240 clamp
    v_exp_f32_e64 v241, v241 clamp
    v_exp_f32_e64 v242, v242 clamp
    v_exp_f32_e64 v243, v243 clamp
    v_exp_f32_e64 v244, v244 clamp
    v_exp_f32_e64 v245, v245 clamp
    v_exp_f32_e64 v246, v246 clamp
    v_exp_f32_e64 v247, v247 clamp
    v_max_f32 v32, 0, v32
    v_max_f32 v33, 0, v33
    v_max_f32 v34, 0, v34
    v_max_f32 v35, 0, v35
    v_max_f32 v36, 0, v36
    v_max_f32 v37, 0, v37
    v_max_f32 v38, 0, v38
    v_max_f32 v39, 0, v39
    v_pk_add_f32 v[32:33], v[32:33], v[240:241]
    v_pk_add_f32 v[34:35], v[34:35], v[242:243]
    v_pk_add_f32 v[36:37], v[36:37], v[244:245]
    v_pk_add_f32 v[38:39], v[38:39], v[246:247]
    v_pk_add_f32 v[32:33], v[32:33], s[64:65]
    v_pk_add_f32 v[34:35], v[34:35], s[64:65]
    v_pk_add_f32 v[36:37], v[36:37], s[64:65]
    v_pk_add_f32 v[38:39], v[38:39], s[64:65]
    v_cvt_pk_bf16_f32 v88, v32, v33
    v_cvt_pk_bf16_f32 v89, v34, v35
    v_cvt_pk_bf16_f32 v90, v36, v37
    v_cvt_pk_bf16_f32 v91, v38, v39
    v_pk_mul_f32 v[240:241], v[40:41], s[76:77]
    v_pk_mul_f32 v[242:243], v[42:43], s[76:77]
    v_pk_mul_f32 v[244:245], v[44:45], s[76:77]
    v_pk_mul_f32 v[246:247], v[46:47], s[76:77]
    v_exp_f32_e64 v240, v240 clamp
    v_exp_f32_e64 v241, v241 clamp
    v_exp_f32_e64 v242, v242 clamp
    v_exp_f32_e64 v243, v243 clamp
    v_exp_f32_e64 v244, v244 clamp
    v_exp_f32_e64 v245, v245 clamp
    v_exp_f32_e64 v246, v246 clamp
    v_exp_f32_e64 v247, v247 clamp
    v_max_f32 v40, 0, v40
    v_max_f32 v41, 0, v41
    v_max_f32 v42, 0, v42
    v_max_f32 v43, 0, v43
    v_max_f32 v44, 0, v44
    v_max_f32 v45, 0, v45
    v_max_f32 v46, 0, v46
    v_max_f32 v47, 0, v47
    v_pk_add_f32 v[40:41], v[40:41], v[240:241]
    v_pk_add_f32 v[42:43], v[42:43], v[242:243]
    v_pk_add_f32 v[44:45], v[44:45], v[244:245]
    v_pk_add_f32 v[46:47], v[46:47], v[246:247]
    v_pk_add_f32 v[40:41], v[40:41], s[64:65]
    v_pk_add_f32 v[42:43], v[42:43], s[64:65]
    v_pk_add_f32 v[44:45], v[44:45], s[64:65]
    v_pk_add_f32 v[46:47], v[46:47], s[64:65]
    v_cvt_pk_bf16_f32 v92, v40, v41
    v_cvt_pk_bf16_f32 v93, v42, v43
    v_cvt_pk_bf16_f32 v94, v44, v45
    v_cvt_pk_bf16_f32 v95, v46, v47
    v_cvt_pk_bf16_f32 v104, v64, v65
    v_cvt_pk_bf16_f32 v105, v66, v67
    v_cvt_pk_bf16_f32 v106, v68, v69
    v_cvt_pk_bf16_f32 v107, v70, v71
    v_cvt_pk_bf16_f32 v108, v72, v73
    v_cvt_pk_bf16_f32 v109, v74, v75
    v_cvt_pk_bf16_f32 v110, v76, v77
    v_cvt_pk_bf16_f32 v111, v78, v79
    s_nop 1
    v_mfma_f32_32x32x16_bf16 v[32:47], v[88:91], v[104:107], 0
    v_mfma_f32_32x32x16_bf16 v[64:79], v[88:91], v[248:251], 0
    v_mfma_f32_32x32x16_bf16 v[32:47], v[92:95], v[108:111], v[32:47]
    v_mfma_f32_32x32x16_bf16 v[64:79], v[92:95], v[248:251], v[64:79]
    s_nop 1
    v_cndmask_b32 v80, v24, v16, s[74:75]
    v_cndmask_b32 v81, v25, v17, s[74:75]
    v_cndmask_b32 v82, v26, v18, s[74:75]
    v_cndmask_b32 v83, v27, v19, s[74:75]
    v_cndmask_b32 v84, v28, v20, s[74:75]
    v_cndmask_b32 v85, v29, v21, s[74:75]
    v_cndmask_b32 v86, v30, v22, s[74:75]
    v_cndmask_b32 v87, v31, v23, s[74:75]
    v_cndmask_b32 v88, v56, v48, s[74:75]
    v_cndmask_b32 v89, v57, v49, s[74:75]
    v_cndmask_b32 v90, v58, v50, s[74:75]
    v_cndmask_b32 v91, v59, v51, s[74:75]
    v_cndmask_b32 v92, v60, v52, s[74:75]
    v_cndmask_b32 v93, v61, v53, s[74:75]
    v_cndmask_b32 v94, v62, v54, s[74:75]
    v_cndmask_b32 v95, v63, v55, s[74:75]
    ds_write_b128 v12, v[80:83] offset:0
    ds_write_b128 v12, v[84:87] offset:16
    s_mov_b64 s[66:67], exec
    s_mov_b32 exec_lo, 0x00010001
    s_mov_b32 exec_hi, 0x00010001
    ds_write_b128 v14, v[88:91] offset:0
    ds_write_b128 v14, v[92:95] offset:16
    s_mov_b64 exec, s[66:67]
    s_waitcnt lgkmcnt(0)
    s_nop 4
    v_cndmask_b32 v80, v40, v32, s[74:75]
    v_cndmask_b32 v81, v41, v33, s[74:75]
    v_cndmask_b32 v82, v42, v34, s[74:75]
    v_cndmask_b32 v83, v43, v35, s[74:75]
    v_cndmask_b32 v84, v44, v36, s[74:75]
    v_cndmask_b32 v85, v45, v37, s[74:75]
    v_cndmask_b32 v86, v46, v38, s[74:75]
    v_cndmask_b32 v87, v47, v39, s[74:75]
    v_cndmask_b32 v88, v72, v64, s[74:75]
    v_cndmask_b32 v89, v73, v65, s[74:75]
    v_cndmask_b32 v90, v74, v66, s[74:75]
    v_cndmask_b32 v91, v75, v67, s[74:75]
    v_cndmask_b32 v92, v76, v68, s[74:75]
    v_cndmask_b32 v93, v77, v69, s[74:75]
    v_cndmask_b32 v94, v78, v70, s[74:75]
    v_cndmask_b32 v95, v79, v71, s[74:75]
    ds_write_b128 v12, v[80:83] offset:2304
    ds_write_b128 v12, v[84:87] offset:2320
    s_mov_b64 s[66:67], exec
    s_mov_b32 exec_lo, 0x00010001
    s_mov_b32 exec_hi, 0x00010001
    ds_write_b128 v14, v[88:91] offset:2304
    ds_write_b128 v14, v[92:95] offset:2320
    s_mov_b64 exec, s[66:67]
    s_waitcnt lgkmcnt(0)
    s_barrier
    s_add_u32 s69, s37, 0
    s_lshl_b32 s69, s69, 7
    s_add_u32 s69, s69, 7733248
    v_and_b32 v252, 7, v0
    v_lshlrev_b32 v252, 4, v252
    v_add_u32 v252, s69, v252
    buffer_load_dwordx4 v[248:251], v252, s[48:51], 0 offen sc1
    v_mov_b32 v15, 28672
    ds_read_b64 v[254:255], v15
    s_waitcnt lgkmcnt(0)
    v_readfirstlane_b32 s78, v254
    v_readfirstlane_b32 s79, v255
    v_mov_b32 v16, 0
    v_mov_b32 v17, 0
    v_mov_b32 v18, 0
    v_mov_b32 v19, 0
    v_mov_b32 v20, 0
    v_mov_b32 v21, 0
    v_mov_b32 v22, 0
    v_mov_b32 v23, 0
    v_mov_b32 v24, 0
    v_mov_b32 v25, 0
    v_mov_b32 v26, 0
    v_mov_b32 v27, 0
    v_mov_b32 v28, 0
    v_mov_b32 v29, 0
    v_mov_b32 v30, 0
    v_mov_b32 v31, 0
    v_mov_b32 v32, 0
    v_mov_b32 v33, 0
    v_mov_b32 v34, 0
    v_mov_b32 v35, 0
    v_mov_b32 v36, 0
    v_mov_b32 v37, 0
    v_mov_b32 v38, 0
    v_mov_b32 v39, 0
    v_mov_b32 v40, 0
    v_mov_b32 v41, 0
    v_mov_b32 v42, 0
    v_mov_b32 v43, 0
    v_mov_b32 v44, 0
    v_mov_b32 v45, 0
    v_mov_b32 v46, 0
    v_mov_b32 v47, 0
    ds_read_b64_tr_b16 v[80:81], v2 offset:0
    ds_read_b64_tr_b16 v[82:83], v2 offset:512
    ds_read_b64_tr_b16 v[84:85], v3 offset:0
    ds_read_b64_tr_b16 v[86:87], v3 offset:512
    ds_read_b64_tr_b16 v[88:89], v2 offset:2048
    ds_read_b64_tr_b16 v[90:91], v2 offset:2560
    ds_read_b64_tr_b16 v[92:93], v3 offset:2048
    ds_read_b64_tr_b16 v[94:95], v3 offset:2560
    ds_read_b64_tr_b16 v[96:97], v2 offset:4096
    ds_read_b64_tr_b16 v[98:99], v2 offset:4608
    ds_read_b64_tr_b16 v[100:101], v3 offset:4096
    ds_read_b64_tr_b16 v[102:103], v3 offset:4608
    s_waitcnt lgkmcnt(10)
    v_mfma_f32_32x32x16_bf16 v[16:31], v[80:83], v[112:115], v[16:31]
    ds_read_b64_tr_b16 v[104:105], v2 offset:6144
    ds_read_b64_tr_b16 v[106:107], v2 offset:6656
    s_waitcnt lgkmcnt(10)
    v_mfma_f32_32x32x16_bf16 v[32:47], v[84:87], v[112:115], v[32:47]
    ds_read_b64_tr_b16 v[108:109], v3 offset:6144
    ds_read_b64_tr_b16 v[110:111], v3 offset:6656
    s_waitcnt lgkmcnt(10)
    v_mfma_f32_32x32x16_bf16 v[16:31], v[88:91], v[116:119], v[16:31]
    ds_read_b64_tr_b16 v[80:81], v2 offset:8192
    ds_read_b64_tr_b16 v[82:83], v2 offset:8704
    s_waitcnt lgkmcnt(10)
    v_mfma_f32_32x32x16_bf16 v[32:47], v[92:95], v[116:119], v[32:47]
    ds_read_b64_tr_b16 v[84:85], v3 offset:8192
    ds_read_b64_tr_b16 v[86:87], v3 offset:8704
    s_waitcnt lgkmcnt(10)
    v_mfma_f32_32x32x16_bf16 v[16:31], v[96:99], v[120:123], v[16:31]
    ds_read_b64_tr_b16 v[88:89], v2 offset:10240
    ds_read_b64_tr_b16 v[90:91], v2 offset:10752
    s_waitcnt lgkmcnt(10)
    v_mfma_f32_32x32x16_bf16 v[32:47], v[100:103], v[120:123], v[32:47]
    ds_read_b64_tr_b16 v[92:93], v3 offset:10240
    ds_read_b64_tr_b16 v[94:95], v3 offset:10752
    s_waitcnt lgkmcnt(10)
    v_mfma_f32_32x32x16_bf16 v[16:31], v[104:107], v[124:127], v[16:31]
    ds_read_b64_tr_b16 v[96:97], v2 offset:12288
    ds_read_b64_tr_b16 v[98:99], v2 offset:12800
    s_waitcnt lgkmcnt(10)
    v_mfma_f32_32x32x16_bf16 v[32:47], v[108:111], v[124:127], v[32:47]
    ds_read_b64_tr_b16 v[100:101], v3 offset:12288
    ds_read_b64_tr_b16 v[102:103], v3 offset:12800
    s_waitcnt lgkmcnt(10)
    v_mfma_f32_32x32x16_bf16 v[16:31], v[80:83], v[128:131], v[16:31]
    ds_read_b64_tr_b16 v[104:105], v2 offset:14336
    ds_read_b64_tr_b16 v[106:107], v2 offset:14848
    s_waitcnt lgkmcnt(10)
    v_mfma_f32_32x32x16_bf16 v[32:47], v[84:87], v[128:131], v[32:47]
    ds_read_b64_tr_b16 v[108:109], v3 offset:14336
    ds_read_b64_tr_b16 v[110:111], v3 offset:14848
    s_waitcnt lgkmcnt(10)
    v_mfma_f32_32x32x16_bf16 v[16:31], v[88:91], v[132:135], v[16:31]
    ds_read_b64_tr_b16 v[80:81], v2 offset:16384
    ds_read_b64_tr_b16 v[82:83], v2 offset:16896
    s_waitcnt lgkmcnt(10)
    v_mfma_f32_32x32x16_bf16 v[32:47], v[92:95], v[132:135], v[32:47]
    ds_read_b64_tr_b16 v[84:85], v3 offset:16384
    ds_read_b64_tr_b16 v[86:87], v3 offset:16896
    s_waitcnt lgkmcnt(10)
    v_mfma_f32_32x32x16_bf16 v[16:31], v[96:99], v[136:139], v[16:31]
    ds_read_b64_tr_b16 v[88:89], v2 offset:18432
    ds_read_b64_tr_b16 v[90:91], v2 offset:18944
    s_waitcnt lgkmcnt(10)
    v_mfma_f32_32x32x16_bf16 v[32:47], v[100:103], v[136:139], v[32:47]
    ds_read_b64_tr_b16 v[92:93], v3 offset:18432
    ds_read_b64_tr_b16 v[94:95], v3 offset:18944
    s_waitcnt lgkmcnt(10)
    v_mfma_f32_32x32x16_bf16 v[16:31], v[104:107], v[140:143], v[16:31]
    ds_read_b64_tr_b16 v[96:97], v2 offset:20480
    ds_read_b64_tr_b16 v[98:99], v2 offset:20992
    s_waitcnt lgkmcnt(10)
    v_mfma_f32_32x32x16_bf16 v[32:47], v[108:111], v[140:143], v[32:47]
    ds_read_b64_tr_b16 v[100:101], v3 offset:20480
    ds_read_b64_tr_b16 v[102:103], v3 offset:20992
    s_waitcnt lgkmcnt(10)
    v_mfma_f32_32x32x16_bf16 v[16:31], v[80:83], v[144:147], v[16:31]
    ds_read_b64_tr_b16 v[104:105], v2 offset:22528
    ds_read_b64_tr_b16 v[106:107], v2 offset:23040
    s_waitcnt lgkmcnt(10)
    v_mfma_f32_32x32x16_bf16 v[32:47], v[84:87], v[144:147], v[32:47]
    ds_read_b64_tr_b16 v[108:109], v3 offset:22528
    ds_read_b64_tr_b16 v[110:111], v3 offset:23040
    s_waitcnt lgkmcnt(10)
    v_mfma_f32_32x32x16_bf16 v[16:31], v[88:91], v[148:151], v[16:31]
    ds_read_b64_tr_b16 v[80:81], v2 offset:24576
    ds_read_b64_tr_b16 v[82:83], v2 offset:25088
    s_waitcnt lgkmcnt(10)
    v_mfma_f32_32x32x16_bf16 v[32:47], v[92:95], v[148:151], v[32:47]
    ds_read_b64_tr_b16 v[84:85], v3 offset:24576
    ds_read_b64_tr_b16 v[86:87], v3 offset:25088
    s_waitcnt lgkmcnt(10)
    v_mfma_f32_32x32x16_bf16 v[16:31], v[96:99], v[152:155], v[16:31]
    ds_read_b64_tr_b16 v[88:89], v2 offset:26624
    ds_read_b64_tr_b16 v[90:91], v2 offset:27136
    s_waitcnt lgkmcnt(10)
    v_mfma_f32_32x32x16_bf16 v[32:47], v[100:103], v[152:155], v[32:47]
    ds_read_b64_tr_b16 v[92:93], v3 offset:26624
    ds_read_b64_tr_b16 v[94:95], v3 offset:27136
    s_waitcnt lgkmcnt(10)
    v_mfma_f32_32x32x16_bf16 v[16:31], v[104:107], v[156:159], v[16:31]
    ds_read_b64_tr_b16 v[96:97], v2 offset:28672
    ds_read_b64_tr_b16 v[98:99], v2 offset:29184
    s_waitcnt lgkmcnt(10)
    v_mfma_f32_32x32x16_bf16 v[32:47], v[108:111], v[156:159], v[32:47]
    ds_read_b64_tr_b16 v[100:101], v3 offset:28672
    ds_read_b64_tr_b16 v[102:103], v3 offset:29184
    s_waitcnt lgkmcnt(10)
    v_mfma_f32_32x32x16_bf16 v[16:31], v[80:83], v[160:163], v[16:31]
    ds_read_b64_tr_b16 v[104:105], v2 offset:30720
    ds_read_b64_tr_b16 v[106:107], v2 offset:31232
    s_waitcnt lgkmcnt(10)
    v_mfma_f32_32x32x16_bf16 v[32:47], v[84:87], v[160:163], v[32:47]
    ds_read_b64_tr_b16 v[108:109], v3 offset:30720
    ds_read_b64_tr_b16 v[110:111], v3 offset:31232
    s_waitcnt lgkmcnt(10)
    v_mfma_f32_32x32x16_bf16 v[16:31], v[88:91], v[164:167], v[16:31]
    ds_read_b64_tr_b16 v[80:81], v2 offset:32768
    ds_read_b64_tr_b16 v[82:83], v2 offset:33280
    s_waitcnt lgkmcnt(10)
    v_mfma_f32_32x32x16_bf16 v[32:47], v[92:95], v[164:167], v[32:47]
    ds_read_b64_tr_b16 v[84:85], v3 offset:32768
    ds_read_b64_tr_b16 v[86:87], v3 offset:33280
    s_waitcnt lgkmcnt(10)
    v_mfma_f32_32x32x16_bf16 v[16:31], v[96:99], v[168:171], v[16:31]
    ds_read_b64_tr_b16 v[88:89], v2 offset:34816
    ds_read_b64_tr_b16 v[90:91], v2 offset:35328
    s_waitcnt lgkmcnt(10)
    v_mfma_f32_32x32x16_bf16 v[32:47], v[100:103], v[168:171], v[32:47]
    ds_read_b64_tr_b16 v[92:93], v3 offset:34816
    ds_read_b64_tr_b16 v[94:95], v3 offset:35328
    s_waitcnt lgkmcnt(10)
    v_mfma_f32_32x32x16_bf16 v[16:31], v[104:107], v[172:175], v[16:31]
    ds_read_b64_tr_b16 v[96:97], v2 offset:36864
    ds_read_b64_tr_b16 v[98:99], v2 offset:37376
    s_waitcnt lgkmcnt(10)
    v_mfma_f32_32x32x16_bf16 v[32:47], v[108:111], v[172:175], v[32:47]
    ds_read_b64_tr_b16 v[100:101], v3 offset:36864
    ds_read_b64_tr_b16 v[102:103], v3 offset:37376
    s_waitcnt lgkmcnt(10)
    v_mfma_f32_32x32x16_bf16 v[16:31], v[80:83], v[176:179], v[16:31]
    ds_read_b64_tr_b16 v[104:105], v2 offset:38912
    ds_read_b64_tr_b16 v[106:107], v2 offset:39424
    s_waitcnt lgkmcnt(10)
    v_mfma_f32_32x32x16_bf16 v[32:47], v[84:87], v[176:179], v[32:47]
    ds_read_b64_tr_b16 v[108:109], v3 offset:38912
    ds_read_b64_tr_b16 v[110:111], v3 offset:39424
    s_waitcnt lgkmcnt(10)
    v_mfma_f32_32x32x16_bf16 v[16:31], v[88:91], v[180:183], v[16:31]
    ds_read_b64_tr_b16 v[80:81], v2 offset:40960
    ds_read_b64_tr_b16 v[82:83], v2 offset:41472
    s_waitcnt lgkmcnt(10)
    v_mfma_f32_32x32x16_bf16 v[32:47], v[92:95], v[180:183], v[32:47]
    ds_read_b64_tr_b16 v[84:85], v3 offset:40960
    ds_read_b64_tr_b16 v[86:87], v3 offset:41472
    s_waitcnt lgkmcnt(10)
    v_mfma_f32_32x32x16_bf16 v[16:31], v[96:99], v[184:187], v[16:31]
    ds_read_b64_tr_b16 v[88:89], v2 offset:43008
    ds_read_b64_tr_b16 v[90:91], v2 offset:43520
    s_waitcnt lgkmcnt(10)
    v_mfma_f32_32x32x16_bf16 v[32:47], v[100:103], v[184:187], v[32:47]
    ds_read_b64_tr_b16 v[92:93], v3 offset:43008
    ds_read_b64_tr_b16 v[94:95], v3 offset:43520
    s_waitcnt lgkmcnt(10)
    v_mfma_f32_32x32x16_bf16 v[16:31], v[104:107], v[188:191], v[16:31]
    ds_read_b64_tr_b16 v[96:97], v2 offset:45056
    ds_read_b64_tr_b16 v[98:99], v2 offset:45568
    s_waitcnt lgkmcnt(10)
    v_mfma_f32_32x32x16_bf16 v[32:47], v[108:111], v[188:191], v[32:47]
    ds_read_b64_tr_b16 v[100:101], v3 offset:45056
    ds_read_b64_tr_b16 v[102:103], v3 offset:45568
    s_waitcnt lgkmcnt(10)
    v_mfma_f32_32x32x16_bf16 v[16:31], v[80:83], v[192:195], v[16:31]
    ds_read_b64_tr_b16 v[104:105], v2 offset:47104
    ds_read_b64_tr_b16 v[106:107], v2 offset:47616
    s_waitcnt lgkmcnt(10)
    v_mfma_f32_32x32x16_bf16 v[32:47], v[84:87], v[192:195], v[32:47]
    ds_read_b64_tr_b16 v[108:109], v3 offset:47104
    ds_read_b64_tr_b16 v[110:111], v3 offset:47616
    s_waitcnt lgkmcnt(10)
    v_mfma_f32_32x32x16_bf16 v[16:31], v[88:91], v[196:199], v[16:31]
    ds_read_b64_tr_b16 v[80:81], v2 offset:49152
    ds_read_b64_tr_b16 v[82:83], v2 offset:49664
    s_waitcnt lgkmcnt(10)
    v_mfma_f32_32x32x16_bf16 v[32:47], v[92:95], v[196:199], v[32:47]
    ds_read_b64_tr_b16 v[84:85], v3 offset:49152
    ds_read_b64_tr_b16 v[86:87], v3 offset:49664
    s_waitcnt lgkmcnt(10)
    v_mfma_f32_32x32x16_bf16 v[16:31], v[96:99], v[200:203], v[16:31]
    ds_read_b64_tr_b16 v[88:89], v2 offset:51200
    ds_read_b64_tr_b16 v[90:91], v2 offset:51712
    s_waitcnt lgkmcnt(10)
    v_mfma_f32_32x32x16_bf16 v[32:47], v[100:103], v[200:203], v[32:47]
    ds_read_b64_tr_b16 v[92:93], v3 offset:51200
    ds_read_b64_tr_b16 v[94:95], v3 offset:51712
    s_waitcnt lgkmcnt(10)
    v_mfma_f32_32x32x16_bf16 v[16:31], v[104:107], v[204:207], v[16:31]
    ds_read_b64_tr_b16 v[96:97], v2 offset:53248
    ds_read_b64_tr_b16 v[98:99], v2 offset:53760
    s_waitcnt lgkmcnt(10)
    v_mfma_f32_32x32x16_bf16 v[32:47], v[108:111], v[204:207], v[32:47]
    ds_read_b64_tr_b16 v[100:101], v3 offset:53248
    ds_read_b64_tr_b16 v[102:103], v3 offset:53760
    s_waitcnt lgkmcnt(10)
    v_mfma_f32_32x32x16_bf16 v[16:31], v[80:83], v[208:211], v[16:31]
    ds_read_b64_tr_b16 v[104:105], v2 offset:55296
    ds_read_b64_tr_b16 v[106:107], v2 offset:55808
    s_waitcnt lgkmcnt(10)
    v_mfma_f32_32x32x16_bf16 v[32:47], v[84:87], v[208:211], v[32:47]
    ds_read_b64_tr_b16 v[108:109], v3 offset:55296
    ds_read_b64_tr_b16 v[110:111], v3 offset:55808
    s_waitcnt lgkmcnt(10)
    v_mfma_f32_32x32x16_bf16 v[16:31], v[88:91], v[212:215], v[16:31]
    ds_read_b64_tr_b16 v[80:81], v2 offset:57344
    ds_read_b64_tr_b16 v[82:83], v2 offset:57856
    s_waitcnt lgkmcnt(10)
    v_mfma_f32_32x32x16_bf16 v[32:47], v[92:95], v[212:215], v[32:47]
    ds_read_b64_tr_b16 v[84:85], v3 offset:57344
    ds_read_b64_tr_b16 v[86:87], v3 offset:57856
    s_waitcnt lgkmcnt(10)
    v_mfma_f32_32x32x16_bf16 v[16:31], v[96:99], v[216:219], v[16:31]
    ds_read_b64_tr_b16 v[88:89], v2 offset:59392
    ds_read_b64_tr_b16 v[90:91], v2 offset:59904
    s_waitcnt lgkmcnt(10)
    v_mfma_f32_32x32x16_bf16 v[32:47], v[100:103], v[216:219], v[32:47]
    ds_read_b64_tr_b16 v[92:93], v3 offset:59392
    ds_read_b64_tr_b16 v[94:95], v3 offset:59904
    s_waitcnt lgkmcnt(10)
    v_mfma_f32_32x32x16_bf16 v[16:31], v[104:107], v[220:223], v[16:31]
    ds_read_b64_tr_b16 v[96:97], v2 offset:61440
    ds_read_b64_tr_b16 v[98:99], v2 offset:61952
    s_waitcnt lgkmcnt(10)
    v_mfma_f32_32x32x16_bf16 v[32:47], v[108:111], v[220:223], v[32:47]
    ds_read_b64_tr_b16 v[100:101], v3 offset:61440
    ds_read_b64_tr_b16 v[102:103], v3 offset:61952
    s_waitcnt lgkmcnt(10)
    v_mfma_f32_32x32x16_bf16 v[16:31], v[80:83], v[224:227], v[16:31]
    ds_read_b64_tr_b16 v[104:105], v2 offset:63488
    ds_read_b64_tr_b16 v[106:107], v2 offset:64000
    s_waitcnt lgkmcnt(10)
    v_mfma_f32_32x32x16_bf16 v[32:47], v[84:87], v[224:227], v[32:47]
    ds_read_b64_tr_b16 v[108:109], v3 offset:63488
    ds_read_b64_tr_b16 v[110:111], v3 offset:64000
    s_waitcnt lgkmcnt(10)
    v_mfma_f32_32x32x16_bf16 v[16:31], v[88:91], v[228:231], v[16:31]
    s_waitcnt lgkmcnt(8)
    v_mfma_f32_32x32x16_bf16 v[32:47], v[92:95], v[228:231], v[32:47]
    s_waitcnt lgkmcnt(6)
    v_mfma_f32_32x32x16_bf16 v[16:31], v[96:99], v[232:235], v[16:31]
    s_waitcnt lgkmcnt(4)
    v_mfma_f32_32x32x16_bf16 v[32:47], v[100:103], v[232:235], v[32:47]
    s_waitcnt lgkmcnt(2)
    v_mfma_f32_32x32x16_bf16 v[16:31], v[104:107], v[236:239], v[16:31]
    s_waitcnt lgkmcnt(0)
    v_mfma_f32_32x32x16_bf16 v[32:47], v[108:111], v[236:239], v[32:47]
    s_mov_b32 s64, 0x358637bd
    s_mov_b32 s65, 0x358637bd
    v_mov_b32 v128, 0
    v_mov_b32 v129, 0
    v_mov_b32 v130, 0
    v_mov_b32 v131, 0
    v_mov_b32 v132, 0
    v_mov_b32 v133, 0
    v_mov_b32 v134, 0
    v_mov_b32 v135, 0
    v_mov_b32 v136, 0
    v_mov_b32 v137, 0
    v_mov_b32 v138, 0
    v_mov_b32 v139, 0
    v_mov_b32 v140, 0
    v_mov_b32 v141, 0
    v_mov_b32 v142, 0
    v_mov_b32 v143, 0
    v_mov_b32 v144, 0
    v_mov_b32 v145, 0
    v_mov_b32 v146, 0
    v_mov_b32 v147, 0
    v_mov_b32 v148, 0
    v_mov_b32 v149, 0
    v_mov_b32 v150, 0
    v_mov_b32 v151, 0
    v_mov_b32 v152, 0
    v_mov_b32 v153, 0
    v_mov_b32 v154, 0
    v_mov_b32 v155, 0
    v_mov_b32 v156, 0
    v_mov_b32 v157, 0
    v_mov_b32 v158, 0
    v_mov_b32 v159, 0
    v_pk_mul_f32 v[240:241], v[16:17], s[76:77]
    v_pk_mul_f32 v[242:243], v[18:19], s[76:77]
    v_pk_mul_f32 v[244:245], v[20:21], s[76:77]
    v_pk_mul_f32 v[246:247], v[22:23], s[76:77]
    v_exp_f32_e64 v240, v240 clamp
    v_exp_f32_e64 v241, v241 clamp
    v_exp_f32_e64 v242, v242 clamp
    v_exp_f32_e64 v243, v243 clamp
    v_exp_f32_e64 v244, v244 clamp
    v_exp_f32_e64 v245, v245 clamp
    v_exp_f32_e64 v246, v246 clamp
    v_exp_f32_e64 v247, v247 clamp
    v_max_f32 v16, 0, v16
    v_max_f32 v17, 0, v17
    v_max_f32 v18, 0, v18
    v_max_f32 v19, 0, v19
    v_max_f32 v20, 0, v20
    v_max_f32 v21, 0, v21
    v_max_f32 v22, 0, v22
    v_max_f32 v23, 0, v23
    v_pk_add_f32 v[16:17], v[16:17], v[240:241]
    v_pk_add_f32 v[18:19], v[18:19], v[242:243]
    v_pk_add_f32 v[20:21], v[20:21], v[244:245]
    v_pk_add_f32 v[22:23], v[22:23], v[246:247]
    v_pk_add_f32 v[16:17], v[16:17], s[64:65]
    v_pk_add_f32 v[18:19], v[18:19], s[64:65]
    v_pk_add_f32 v[20:21], v[20:21], s[64:65]
    v_pk_add_f32 v[22:23], v[22:23], s[64:65]
    v_cvt_pk_bf16_f32 v80, v16, v17
    v_cvt_pk_bf16_f32 v81, v18, v19
    v_cvt_pk_bf16_f32 v82, v20, v21
    v_cvt_pk_bf16_f32 v83, v22, v23
    v_pk_mul_f32 v[240:241], v[24:25], s[76:77]
    v_pk_mul_f32 v[242:243], v[26:27], s[76:77]
    v_pk_mul_f32 v[244:245], v[28:29], s[76:77]
    v_pk_mul_f32 v[246:247], v[30:31], s[76:77]
    v_exp_f32_e64 v240, v240 clamp
    v_exp_f32_e64 v241, v241 clamp
    v_exp_f32_e64 v242, v242 clamp
    v_exp_f32_e64 v243, v243 clamp
    v_exp_f32_e64 v244, v244 clamp
    v_exp_f32_e64 v245, v245 clamp
    v_exp_f32_e64 v246, v246 clamp
    v_exp_f32_e64 v247, v247 clamp
    v_max_f32 v24, 0, v24
    v_max_f32 v25, 0, v25
    v_max_f32 v26, 0, v26
    v_max_f32 v27, 0, v27
    v_max_f32 v28, 0, v28
    v_max_f32 v29, 0, v29
    v_max_f32 v30, 0, v30
    v_max_f32 v31, 0, v31
    v_pk_add_f32 v[24:25], v[24:25], v[240:241]
    v_pk_add_f32 v[26:27], v[26:27], v[242:243]
    v_pk_add_f32 v[28:29], v[28:29], v[244:245]
    v_pk_add_f32 v[30:31], v[30:31], v[246:247]
    v_pk_add_f32 v[24:25], v[24:25], s[64:65]
    v_pk_add_f32 v[26:27], v[26:27], s[64:65]
    v_pk_add_f32 v[28:29], v[28:29], s[64:65]
    v_pk_add_f32 v[30:31], v[30:31], s[64:65]
    v_cvt_pk_bf16_f32 v84, v24, v25
    v_cvt_pk_bf16_f32 v85, v26, v27
    v_cvt_pk_bf16_f32 v86, v28, v29
    v_cvt_pk_bf16_f32 v87, v30, v31
    v_pk_mul_f32 v[240:241], v[32:33], s[76:77]
    v_pk_mul_f32 v[242:243], v[34:35], s[76:77]
    v_pk_mul_f32 v[244:245], v[36:37], s[76:77]
    v_pk_mul_f32 v[246:247], v[38:39], s[76:77]
    v_exp_f32_e64 v240, v240 clamp
    v_exp_f32_e64 v241, v241 clamp
    v_exp_f32_e64 v242, v242 clamp
    v_exp_f32_e64 v243, v243 clamp
    v_exp_f32_e64 v244, v244 clamp
    v_exp_f32_e64 v245, v245 clamp
    v_exp_f32_e64 v246, v246 clamp
    v_exp_f32_e64 v247, v247 clamp
    v_max_f32 v32, 0, v32
    v_max_f32 v33, 0, v33
    v_max_f32 v34, 0, v34
    v_max_f32 v35, 0, v35
    v_max_f32 v36, 0, v36
    v_max_f32 v37, 0, v37
    v_max_f32 v38, 0, v38
    v_max_f32 v39, 0, v39
    v_pk_add_f32 v[32:33], v[32:33], v[240:241]
    v_pk_add_f32 v[34:35], v[34:35], v[242:243]
    v_pk_add_f32 v[36:37], v[36:37], v[244:245]
    v_pk_add_f32 v[38:39], v[38:39], v[246:247]
    v_pk_add_f32 v[32:33], v[32:33], s[64:65]
    v_pk_add_f32 v[34:35], v[34:35], s[64:65]
    v_pk_add_f32 v[36:37], v[36:37], s[64:65]
    v_pk_add_f32 v[38:39], v[38:39], s[64:65]
    v_cvt_pk_bf16_f32 v88, v32, v33
    v_cvt_pk_bf16_f32 v89, v34, v35
    v_cvt_pk_bf16_f32 v90, v36, v37
    v_cvt_pk_bf16_f32 v91, v38, v39
    v_pk_mul_f32 v[240:241], v[40:41], s[76:77]
    v_pk_mul_f32 v[242:243], v[42:43], s[76:77]
    v_pk_mul_f32 v[244:245], v[44:45], s[76:77]
    v_pk_mul_f32 v[246:247], v[46:47], s[76:77]
    v_exp_f32_e64 v240, v240 clamp
    v_exp_f32_e64 v241, v241 clamp
    v_exp_f32_e64 v242, v242 clamp
    v_exp_f32_e64 v243, v243 clamp
    v_exp_f32_e64 v244, v244 clamp
    v_exp_f32_e64 v245, v245 clamp
    v_exp_f32_e64 v246, v246 clamp
    v_exp_f32_e64 v247, v247 clamp
    v_max_f32 v40, 0, v40
    v_max_f32 v41, 0, v41
    v_max_f32 v42, 0, v42
    v_max_f32 v43, 0, v43
    v_max_f32 v44, 0, v44
    v_max_f32 v45, 0, v45
    v_max_f32 v46, 0, v46
    v_max_f32 v47, 0, v47
    v_pk_add_f32 v[40:41], v[40:41], v[240:241]
    v_pk_add_f32 v[42:43], v[42:43], v[242:243]
    v_pk_add_f32 v[44:45], v[44:45], v[244:245]
    v_pk_add_f32 v[46:47], v[46:47], v[246:247]
    v_pk_add_f32 v[40:41], v[40:41], s[64:65]
    v_pk_add_f32 v[42:43], v[42:43], s[64:65]
    v_pk_add_f32 v[44:45], v[44:45], s[64:65]
    v_pk_add_f32 v[46:47], v[46:47], s[64:65]
    v_cvt_pk_bf16_f32 v92, v40, v41
    v_cvt_pk_bf16_f32 v93, v42, v43
    v_cvt_pk_bf16_f32 v94, v44, v45
    v_cvt_pk_bf16_f32 v95, v46, v47
    v_lshlrev_b32 v13, 4, v11
    v_add_u32 v13, v13, v10
    v_lshlrev_b32 v13, 4, v13
    v_lshlrev_b32 v15, 4, v11
    v_add_u32 v15, 512, v15
    v_cndmask_b32 v13, v15, v13, s[74:75]
    v_add_u32 v13, 20480, v13
    v_lshlrev_b32 v12, 4, v0
    s_lshl_b32 s64, s37, 2
    s_add_u32 s64, s64, s3
    s_lshl_b32 s64, s64, 5
    s_lshl_b32 s65, s38, 2
    s_add_u32 s64, s64, s65
    s_lshl_b32 s64, s64, 10
    s_waitcnt vmcnt(0)
    s_mov_b32 s72, 262144
    s_mov_b32 s73, 0
concat_heads__linear_attn_block__ssm_conv_s5__prompt_kernel_mode_lp_qc:
    v_xor_b32 v248, s78, v248
    v_xor_b32 v249, s79, v249
    v_or_b32 v248, v248, v249
    v_cmp_ne_u32 vcc, 0, v248
    s_cbranch_vccz concat_heads__linear_attn_block__ssm_conv_s5__prompt_kernel_mode_ok_qc
    s_sub_u32 s72, s72, 1
    s_cbranch_scc1 concat_heads__linear_attn_block__ssm_conv_s5__prompt_kernel_mode_to_qc
    buffer_load_dwordx4 v[248:251], v252, s[48:51], 0 offen sc1
    s_waitcnt vmcnt(0)
    s_branch concat_heads__linear_attn_block__ssm_conv_s5__prompt_kernel_mode_lp_qc
concat_heads__linear_attn_block__ssm_conv_s5__prompt_kernel_mode_ok_qc:
    s_getreg_b32 s70, hwreg(HW_REG_XCC_ID, 0, 4)
    v_cmp_ne_u32 vcc, s70, v250
    s_cmp_eq_u64 vcc, 0
    s_cselect_b32 s73, 1, 0
concat_heads__linear_attn_block__ssm_conv_s5__prompt_kernel_mode_to_qc:
    s_barrier
    v_mov_b32 v15, 28672
    ds_read_b64 v[250:251], v15
    ds_read_b128 v[96:99], v13 offset:0
    ds_read_b128 v[100:103], v13 offset:1024
    ds_read_b128 v[104:107], v13 offset:2048
    ds_read_b128 v[108:111], v13 offset:3072
    s_waitcnt lgkmcnt(3)
    v_mfma_f32_32x32x16_bf16 v[16:31], v[96:99], v[80:83], 0
    s_waitcnt lgkmcnt(2)
    v_mfma_f32_32x32x16_bf16 v[32:47], v[100:103], v[84:87], 0
    s_waitcnt lgkmcnt(1)
    v_mfma_f32_32x32x16_bf16 v[48:63], v[104:107], v[88:91], 0
    s_waitcnt lgkmcnt(0)
    v_mfma_f32_32x32x16_bf16 v[64:79], v[108:111], v[92:95], 0
    s_nop 7
    v_add_f32 v24, 0x358637bd, v24
    v_add_f32 v40, 0x358637bd, v40
    v_add_f32 v56, 0x358637bd, v56
    s_nop 3
    v_add_f32 v72, 0x358637bd, v72
    v_rcp_f32 v24, v24
    v_rcp_f32 v40, v40
    v_rcp_f32 v56, v56
    v_rcp_f32 v72, v72
    s_nop 0
    v_pk_mul_f32 v[16:17], v[16:17], v[24:25] op_sel_hi:[1,0]
    v_pk_mul_f32 v[18:19], v[18:19], v[24:25] op_sel_hi:[1,0]
    v_pk_mul_f32 v[20:21], v[20:21], v[24:25] op_sel_hi:[1,0]
    v_pk_mul_f32 v[22:23], v[22:23], v[24:25] op_sel_hi:[1,0]
    v_cvt_pk_bf16_f32 v28, v16, v17
    v_cvt_pk_bf16_f32 v29, v18, v19
    v_cvt_pk_bf16_f32 v30, v20, v21
    v_cvt_pk_bf16_f32 v31, v22, v23
    v_pk_mul_f32 v[32:33], v[32:33], v[40:41] op_sel_hi:[1,0]
    v_pk_mul_f32 v[34:35], v[34:35], v[40:41] op_sel_hi:[1,0]
    v_pk_mul_f32 v[36:37], v[36:37], v[40:41] op_sel_hi:[1,0]
    v_pk_mul_f32 v[38:39], v[38:39], v[40:41] op_sel_hi:[1,0]
    v_cvt_pk_bf16_f32 v44, v32, v33
    v_cvt_pk_bf16_f32 v45, v34, v35
    v_cvt_pk_bf16_f32 v46, v36, v37
    v_cvt_pk_bf16_f32 v47, v38, v39
    v_pk_mul_f32 v[48:49], v[48:49], v[56:57] op_sel_hi:[1,0]
    v_pk_mul_f32 v[50:51], v[50:51], v[56:57] op_sel_hi:[1,0]
    v_pk_mul_f32 v[52:53], v[52:53], v[56:57] op_sel_hi:[1,0]
    v_pk_mul_f32 v[54:55], v[54:55], v[56:57] op_sel_hi:[1,0]
    v_cvt_pk_bf16_f32 v60, v48, v49
    v_cvt_pk_bf16_f32 v61, v50, v51
    v_cvt_pk_bf16_f32 v62, v52, v53
    v_cvt_pk_bf16_f32 v63, v54, v55
    v_pk_mul_f32 v[64:65], v[64:65], v[72:73] op_sel_hi:[1,0]
    v_pk_mul_f32 v[66:67], v[66:67], v[72:73] op_sel_hi:[1,0]
    v_pk_mul_f32 v[68:69], v[68:69], v[72:73] op_sel_hi:[1,0]
    v_pk_mul_f32 v[70:71], v[70:71], v[72:73] op_sel_hi:[1,0]
    v_cvt_pk_bf16_f32 v76, v64, v65
    v_cvt_pk_bf16_f32 v77, v66, v67
    v_cvt_pk_bf16_f32 v78, v68, v69
    v_cvt_pk_bf16_f32 v79, v70, v71
    s_cmp_eq_u32 s73, 1
    s_cbranch_scc1 concat_heads__linear_attn_block__ssm_conv_s5__prompt_kernel_o_fast
    buffer_store_dwordx4 v[28:31], v12, s[48:51], s64 offen offset:0 sc1
    buffer_store_dwordx4 v[44:47], v12, s[48:51], s64 offen offset:1024 sc1
    buffer_store_dwordx4 v[60:63], v12, s[48:51], s64 offen offset:2048 sc1
    buffer_store_dwordx4 v[76:79], v12, s[48:51], s64 offen offset:3072 sc1
    s_branch concat_heads__linear_attn_block__ssm_conv_s5__prompt_kernel_o_j
concat_heads__linear_attn_block__ssm_conv_s5__prompt_kernel_o_fast:
    buffer_store_dwordx4 v[28:31], v12, s[48:51], s64 offen offset:0 nt
    buffer_store_dwordx4 v[44:47], v12, s[48:51], s64 offen offset:1024 nt
    buffer_store_dwordx4 v[60:63], v12, s[48:51], s64 offen offset:2048 nt
    buffer_store_dwordx4 v[76:79], v12, s[48:51], s64 offen offset:3072 nt
concat_heads__linear_attn_block__ssm_conv_s5__prompt_kernel_o_j:
    v_readfirstlane_b32 s78, v250
    v_readfirstlane_b32 s79, v251
    s_barrier
    s_waitcnt vmcnt(0)
    s_add_u32 s64, s37, 0
    s_lshl_b32 s64, s64, 10
    s_add_u32 s64, s64, 7602176
    s_lshl_b32 s65, s38, 7
    s_add_u32 s64, s64, s65
    s_lshl_b32 s65, s3, 3
    s_add_u32 s64, s64, s65
    v_mov_b32 v12, 0
    s_mov_b64 s[74:75], exec
    s_mov_b64 exec, 1
    s_cmp_eq_u32 s73, 1
    s_cbranch_scc1 concat_heads__linear_attn_block__ssm_conv_s5__prompt_kernel_wf_fast_A
    buffer_store_dwordx2 v[250:251], v12, s[48:51], s64 offen sc1
    s_branch concat_heads__linear_attn_block__ssm_conv_s5__prompt_kernel_wf_j_A
concat_heads__linear_attn_block__ssm_conv_s5__prompt_kernel_wf_fast_A:
    buffer_store_dwordx2 v[250:251], v12, s[48:51], s64 offen
concat_heads__linear_attn_block__ssm_conv_s5__prompt_kernel_wf_j_A:
    s_mov_b64 exec, s[74:75]
    s_branch concat_heads__linear_attn_block__ssm_conv_s5__prompt_kernel_p2A
concat_heads__linear_attn_block__ssm_conv_s5__prompt_kernel_bu:
    v_and_b32 v10, 15, v0
    v_lshrrev_b32 v11, 4, v0
    s_lshl_b32 s64, s38, 6
    s_lshl_b32 s65, s3, 4
    s_add_u32 s64, s64, s65
    s_lshl_b32 s64, s64, 1
    v_lshlrev_b32 v12, 1, v10
    v_lshrrev_b32 v13, 1, v10
    v_xor_b32 v13, v13, v11
    v_lshlrev_b32 v13, 4, v13
    v_lshlrev_b32 v14, 7, v10
    v_add_u32 v4, v13, v14
    v_xor_b32 v5, 64, v4
    s_lshl_b32 s65, s3, 11
    s_add_u32 s65, s65, 16384
    v_add_u32 v6, s65, v4
    v_add_u32 v7, s65, v5
    v_mov_b32 v16, 0
    v_mov_b32 v17, 0
    v_mov_b32 v18, 0
    v_mov_b32 v19, 0
    v_mov_b32 v20, 0
    v_mov_b32 v21, 0
    v_mov_b32 v22, 0
    v_mov_b32 v23, 0
    v_mov_b32 v24, 0
    v_mov_b32 v25, 0
    v_mov_b32 v26, 0
    v_mov_b32 v27, 0
    v_mov_b32 v28, 0
    v_mov_b32 v29, 0
    v_mov_b32 v30, 0
    v_mov_b32 v31, 0
    v_mov_b32 v32, 0
    v_mov_b32 v33, 0
    v_mov_b32 v34, 0
    v_mov_b32 v35, 0
    v_mov_b32 v36, 0
    v_mov_b32 v37, 0
    v_mov_b32 v38, 0
    v_mov_b32 v39, 0
    v_mov_b32 v40, 0
    v_mov_b32 v41, 0
    v_mov_b32 v42, 0
    v_mov_b32 v43, 0
    v_mov_b32 v44, 0
    v_mov_b32 v45, 0
    v_mov_b32 v46, 0
    v_mov_b32 v47, 0
    v_mov_b32 v48, 0
    v_mov_b32 v49, 0
    v_mov_b32 v50, 0
    v_mov_b32 v51, 0
    v_mov_b32 v52, 0
    v_mov_b32 v53, 0
    v_mov_b32 v54, 0
    v_mov_b32 v55, 0
    v_mov_b32 v56, 0
    v_mov_b32 v57, 0
    v_mov_b32 v58, 0
    v_mov_b32 v59, 0
    v_mov_b32 v60, 0
    v_mov_b32 v61, 0
    v_mov_b32 v62, 0
    v_mov_b32 v63, 0
    v_mov_b32 v64, 0
    v_mov_b32 v65, 0
    v_mov_b32 v66, 0
    v_mov_b32 v67, 0
    v_mov_b32 v68, 0
    v_mov_b32 v69, 0
    v_mov_b32 v70, 0
    v_mov_b32 v71, 0
    v_mov_b32 v72, 0
    v_mov_b32 v73, 0
    v_mov_b32 v74, 0
    v_mov_b32 v75, 0
    v_mov_b32 v76, 0
    v_mov_b32 v77, 0
    v_mov_b32 v78, 0
    v_mov_b32 v79, 0
    s_waitcnt lgkmcnt(0)
    s_mov_b32 s48, s32
    s_and_b32 s49, s33, 0xffff
    s_mov_b32 s50, 0x10000000
    s_mov_b32 s51, 0x20000
    s_mov_b32 s52, s12
    s_and_b32 s53, s13, 0xffff
    s_mov_b32 s54, 0x400
    s_mov_b32 s55, 0x20000
    s_mov_b32 s56, s14
    s_and_b32 s57, s15, 0xffff
    s_mov_b32 s58, 0x400
    s_mov_b32 s59, 0x20000
    s_mov_b32 s60, s24
    s_and_b32 s61, s25, 0xffff
    s_mov_b32 s62, 0x400
    s_mov_b32 s63, 0x20000
    buffer_load_ushort v160, v12, s[52:55], s64 offen
    buffer_load_ushort v161, v12, s[56:59], s64 offen
    buffer_load_ushort v162, v12, s[60:63], s64 offen
    s_waitcnt vmcnt(0)
    s_add_u32 s64, s37, 16
    s_lshl_b32 s64, s64, 10
    s_add_u32 s64, s64, 7602176
    s_lshl_b32 s65, s38, 7
    s_add_u32 s64, s64, s65
    v_mov_b32 v243, 0
    s_mov_b64 s[74:75], exec
    s_mov_b64 exec, 1
    buffer_load_dword v244, v243, s[48:51], s64 offen sc1
    s_mov_b64 exec, s[74:75]
    v_mov_b32 v252, 0
    s_lshl_b32 s64, s37, 2
    s_add_u32 s64, s64, s3
    s_lshl_b32 s64, s64, 6
    s_lshl_b32 s65, s38, 3
    s_add_u32 s64, s64, s65
    s_lshl_b32 s64, s64, 10
    s_add_u32 s64, s64, 2097152
    buffer_load_dword v253, v252, s[48:51], s64 offen sc1
    s_mov_b32 s52, s28
    s_and_b32 s53, s29, 0xffff
    s_mov_b32 s54, 0x800000
    s_mov_b32 s55, 0x20000
    s_lshl_b32 s64, s37, 7
    s_lshl_b32 s65, s3, 5
    s_add_u32 s64, s64, s65
    s_lshl_b32 s64, s64, 12
    s_lshl_b32 s65, s38, 8
    s_add_u32 s64, s64, s65
    s_add_u32 s64, s64, 2048
    buffer_load_dword v253, v252, s[52:55], s64 offen sc1
    s_mov_b32 s56, s26
    s_and_b32 s57, s27, 0xffff
    s_mov_b32 s58, 0x400
    s_mov_b32 s59, 0x20000
    buffer_load_dword v253, v252, s[56:59], 0 offen sc1
    s_lshl_b32 s64, s2, 2
    s_add_u32 s64, s64, s3
    s_mul_i32 s64, s64, 12
    v_add_u32 v240, s64, v0
    v_lshlrev_b32 v240, 7, v240
    s_mov_b32 s52, s8
    s_and_b32 s53, s9, 0xffff
    s_mov_b32 s54, 0x80000
    s_mov_b32 s55, 0x20000
    s_mov_b32 s56, s20
    s_and_b32 s57, s21, 0xffff
    s_mov_b32 s58, 0x80000
    s_mov_b32 s59, 0x20000
    s_mov_b32 s60, s22
    s_and_b32 s61, s23, 0xffff
    s_mov_b32 s62, 0x80000
    s_mov_b32 s63, 0x20000
    s_mov_b64 s[74:75], exec
    s_mov_b64 exec, 0xfff
    buffer_load_dword v241, v240, s[52:55], 0 offen sc1
    v_subrev_u32 v242, 0x80000, v240
    buffer_load_dword v241, v242, s[56:59], 0 offen sc1
    v_subrev_u32 v242, 0x100000, v240
    buffer_load_dword v241, v242, s[60:63], 0 offen sc1
    s_mov_b64 exec, s[74:75]
    v_lshlrev_b32 v160, 16, v160
    v_lshlrev_b32 v161, 16, v161
    v_lshlrev_b32 v162, 16, v162
    v_mul_f32 v168, 0x3fb8aa3b, v162
    v_exp_f32 v168, v168
    s_nop 0
    v_cvt_pk_bf16_f32 v168, v168, v168
    v_lshlrev_b32 v168, 16, v168
    v_mul_f32 v169, v168, v160
    v_mul_f32 v170, v168, v161
    v_mul_f32 v169, 0x3fb8aa3b, v169
    v_mul_f32 v170, 0x3e22f983, v170
    v_exp_f32 v169, v169
    v_fract_f32 v170, v170
    s_nop 0
    v_cos_f32 v163, v170
    v_sin_f32 v164, v170
    s_nop 0
    v_mul_f32 v163, v163, v169
    v_mul_f32 v164, v164, v169
    v_mov_b32 v166, v163
    v_mov_b32 v167, v164
    v_add_f32 v163, -1.0, v163
    v_mul_f32 v168, v160, v160
    v_fma_f32 v168, v161, v161, v168
    v_rcp_f32 v168, v168
    v_mul_f32 v169, v163, v160
    v_fma_f32 v169, v167, v161, v169
    v_mul_f32 v170, v167, v160
    v_fma_f32 v170, -v163, v161, v170
    v_add_f32 v168, v168, v168
    v_mul_f32 v164, v169, v168
    v_mul_f32 v165, v170, v168
    v_mul_f32 v176, v167, v167
    v_mul_f32 v175, v166, v167
    v_fma_f32 v174, v166, v166, -v176
    v_add_f32 v175, v175, v175
    v_mul_f32 v176, v175, v175
    v_mul_f32 v179, v174, v175
    v_fma_f32 v178, v174, v174, -v176
    v_add_f32 v179, v179, v179
    v_mul_f32 v176, v179, v179
    v_mul_f32 v175, v178, v179
    v_fma_f32 v174, v178, v178, -v176
    v_add_f32 v175, v175, v175
    v_mul_f32 v176, v175, v175
    v_mul_f32 v169, v174, v175
    v_fma_f32 v168, v174, v174, -v176
    v_add_f32 v169, v169, v169
    v_mul_f32 v176, v169, v169
    v_mul_f32 v171, v168, v169
    v_fma_f32 v170, v168, v168, -v176
    v_add_f32 v171, v171, v171
    v_mul_f32 v176, v171, v171
    v_mul_f32 v175, v170, v171
    v_fma_f32 v174, v170, v170, -v176
    v_add_f32 v175, v175, v175
    v_mul_f32 v176, v175, v175
    v_mul_f32 v173, v174, v175
    v_fma_f32 v172, v174, v174, -v176
    v_add_f32 v173, v173, v173
    v_mul_f32 v176, v173, v173
    v_mul_f32 v215, v172, v173
    v_fma_f32 v214, v172, v172, -v176
    v_add_f32 v215, v215, v215
    v_mul_f32 v176, v215, v215
    v_mul_f32 v219, v214, v215
    v_fma_f32 v218, v214, v214, -v176
    v_add_f32 v219, v219, v219
    v_mul_f32 v216, v214, v172
    v_mul_f32 v217, v214, v173
    v_fma_f32 v216, -v215, v173, v216
    v_fma_f32 v217, v215, v172, v217
    s_barrier
    ds_read_b128 v[144:147], v6 offset:0
    ds_read_b128 v[148:151], v6 offset:8192
    ds_read_b128 v[80:83], v4 offset:0
    ds_read_b128 v[84:87], v4 offset:2048
    ds_read_b128 v[88:91], v4 offset:4096
    ds_read_b128 v[92:95], v4 offset:6144
    ds_read_b128 v[96:99], v4 offset:8192
    ds_read_b128 v[100:103], v4 offset:10240
    ds_read_b128 v[104:107], v4 offset:12288
    ds_read_b128 v[108:111], v4 offset:14336
    s_waitcnt lgkmcnt(7)
    v_mfma_f32_16x16x32_bf16 v[16:19], v[80:83], v[144:147], v[16:19]
    v_mfma_f32_16x16x32_bf16 v[48:51], v[80:83], v[148:151], v[48:51]
    ds_read_b128 v[152:155], v7 offset:0
    ds_read_b128 v[156:159], v7 offset:8192
    ds_read_b128 v[112:115], v5 offset:0
    s_waitcnt lgkmcnt(9)
    v_mfma_f32_16x16x32_bf16 v[20:23], v[84:87], v[144:147], v[20:23]
    v_mfma_f32_16x16x32_bf16 v[52:55], v[84:87], v[148:151], v[52:55]
    ds_read_b128 v[116:119], v5 offset:2048
    s_waitcnt lgkmcnt(9)
    v_mfma_f32_16x16x32_bf16 v[24:27], v[88:91], v[144:147], v[24:27]
    v_mfma_f32_16x16x32_bf16 v[56:59], v[88:91], v[148:151], v[56:59]
    ds_read_b128 v[120:123], v5 offset:4096
    s_waitcnt lgkmcnt(9)
    v_mfma_f32_16x16x32_bf16 v[28:31], v[92:95], v[144:147], v[28:31]
    v_mfma_f32_16x16x32_bf16 v[60:63], v[92:95], v[148:151], v[60:63]
    ds_read_b128 v[124:127], v5 offset:6144
    s_waitcnt lgkmcnt(9)
    v_mfma_f32_16x16x32_bf16 v[32:35], v[96:99], v[144:147], v[32:35]
    v_mfma_f32_16x16x32_bf16 v[64:67], v[96:99], v[148:151], v[64:67]
    ds_read_b128 v[128:131], v5 offset:8192
    s_waitcnt lgkmcnt(9)
    v_mfma_f32_16x16x32_bf16 v[36:39], v[100:103], v[144:147], v[36:39]
    v_mfma_f32_16x16x32_bf16 v[68:71], v[100:103], v[148:151], v[68:71]
    ds_read_b128 v[132:135], v5 offset:10240
    s_waitcnt lgkmcnt(9)
    v_mfma_f32_16x16x32_bf16 v[40:43], v[104:107], v[144:147], v[40:43]
    v_mfma_f32_16x16x32_bf16 v[72:75], v[104:107], v[148:151], v[72:75]
    ds_read_b128 v[136:139], v5 offset:12288
    s_waitcnt lgkmcnt(9)
    v_mfma_f32_16x16x32_bf16 v[44:47], v[108:111], v[144:147], v[44:47]
    v_mfma_f32_16x16x32_bf16 v[76:79], v[108:111], v[148:151], v[76:79]
    ds_read_b128 v[140:143], v5 offset:14336
    s_barrier
    v_add_u32 v4, 0x8000, v4
    v_add_u32 v5, 0x8000, v5
    v_add_u32 v6, 0x8000, v6
    v_add_u32 v7, 0x8000, v7
    s_waitcnt lgkmcnt(7)
    v_mfma_f32_16x16x32_bf16 v[16:19], v[112:115], v[152:155], v[16:19]
    v_mfma_f32_16x16x32_bf16 v[48:51], v[112:115], v[156:159], v[48:51]
    ds_read_b128 v[144:147], v6 offset:0
    ds_read_b128 v[148:151], v6 offset:8192
    ds_read_b128 v[80:83], v4 offset:0
    s_waitcnt lgkmcnt(9)
    v_mfma_f32_16x16x32_bf16 v[20:23], v[116:119], v[152:155], v[20:23]
    v_mfma_f32_16x16x32_bf16 v[52:55], v[116:119], v[156:159], v[52:55]
    ds_read_b128 v[84:87], v4 offset:2048
    s_waitcnt lgkmcnt(9)
    v_mfma_f32_16x16x32_bf16 v[24:27], v[120:123], v[152:155], v[24:27]
    v_mfma_f32_16x16x32_bf16 v[56:59], v[120:123], v[156:159], v[56:59]
    ds_read_b128 v[88:91], v4 offset:4096
    s_waitcnt lgkmcnt(9)
    v_mfma_f32_16x16x32_bf16 v[28:31], v[124:127], v[152:155], v[28:31]
    v_mfma_f32_16x16x32_bf16 v[60:63], v[124:127], v[156:159], v[60:63]
    ds_read_b128 v[92:95], v4 offset:6144
    s_waitcnt lgkmcnt(9)
    v_mfma_f32_16x16x32_bf16 v[32:35], v[128:131], v[152:155], v[32:35]
    v_mfma_f32_16x16x32_bf16 v[64:67], v[128:131], v[156:159], v[64:67]
    ds_read_b128 v[96:99], v4 offset:8192
    s_waitcnt lgkmcnt(9)
    v_mfma_f32_16x16x32_bf16 v[36:39], v[132:135], v[152:155], v[36:39]
    v_mfma_f32_16x16x32_bf16 v[68:71], v[132:135], v[156:159], v[68:71]
    ds_read_b128 v[100:103], v4 offset:10240
    s_waitcnt lgkmcnt(9)
    v_mfma_f32_16x16x32_bf16 v[40:43], v[136:139], v[152:155], v[40:43]
    v_mfma_f32_16x16x32_bf16 v[72:75], v[136:139], v[156:159], v[72:75]
    ds_read_b128 v[104:107], v4 offset:12288
    s_waitcnt lgkmcnt(9)
    v_mfma_f32_16x16x32_bf16 v[44:47], v[140:143], v[152:155], v[44:47]
    v_mfma_f32_16x16x32_bf16 v[76:79], v[140:143], v[156:159], v[76:79]
    ds_read_b128 v[108:111], v4 offset:14336
    s_waitcnt lgkmcnt(7)
    v_mfma_f32_16x16x32_bf16 v[16:19], v[80:83], v[144:147], v[16:19]
    v_mfma_f32_16x16x32_bf16 v[48:51], v[80:83], v[148:151], v[48:51]
    ds_read_b128 v[152:155], v7 offset:0
    ds_read_b128 v[156:159], v7 offset:8192
    ds_read_b128 v[112:115], v5 offset:0
    s_waitcnt lgkmcnt(9)
    v_mfma_f32_16x16x32_bf16 v[20:23], v[84:87], v[144:147], v[20:23]
    v_mfma_f32_16x16x32_bf16 v[52:55], v[84:87], v[148:151], v[52:55]
    ds_read_b128 v[116:119], v5 offset:2048
    s_waitcnt lgkmcnt(9)
    v_mfma_f32_16x16x32_bf16 v[24:27], v[88:91], v[144:147], v[24:27]
    v_mfma_f32_16x16x32_bf16 v[56:59], v[88:91], v[148:151], v[56:59]
    ds_read_b128 v[120:123], v5 offset:4096
    s_waitcnt lgkmcnt(9)
    v_mfma_f32_16x16x32_bf16 v[28:31], v[92:95], v[144:147], v[28:31]
    v_mfma_f32_16x16x32_bf16 v[60:63], v[92:95], v[148:151], v[60:63]
    ds_read_b128 v[124:127], v5 offset:6144
    s_waitcnt lgkmcnt(9)
    v_mfma_f32_16x16x32_bf16 v[32:35], v[96:99], v[144:147], v[32:35]
    v_mfma_f32_16x16x32_bf16 v[64:67], v[96:99], v[148:151], v[64:67]
    ds_read_b128 v[128:131], v5 offset:8192
    s_waitcnt lgkmcnt(9)
    v_mfma_f32_16x16x32_bf16 v[36:39], v[100:103], v[144:147], v[36:39]
    v_mfma_f32_16x16x32_bf16 v[68:71], v[100:103], v[148:151], v[68:71]
    ds_read_b128 v[132:135], v5 offset:10240
    s_waitcnt lgkmcnt(9)
    v_mfma_f32_16x16x32_bf16 v[40:43], v[104:107], v[144:147], v[40:43]
    v_mfma_f32_16x16x32_bf16 v[72:75], v[104:107], v[148:151], v[72:75]
    ds_read_b128 v[136:139], v5 offset:12288
    s_waitcnt lgkmcnt(9)
    v_mfma_f32_16x16x32_bf16 v[44:47], v[108:111], v[144:147], v[44:47]
    v_mfma_f32_16x16x32_bf16 v[76:79], v[108:111], v[148:151], v[76:79]
    ds_read_b128 v[140:143], v5 offset:14336
    s_barrier
    v_add_u32 v4, 0x8000, v4
    v_add_u32 v5, 0x8000, v5
    v_add_u32 v6, 0x8000, v6
    v_add_u32 v7, 0x8000, v7
    s_waitcnt lgkmcnt(7)
    v_mfma_f32_16x16x32_bf16 v[16:19], v[112:115], v[152:155], v[16:19]
    v_mfma_f32_16x16x32_bf16 v[48:51], v[112:115], v[156:159], v[48:51]
    ds_read_b128 v[144:147], v6 offset:0
    ds_read_b128 v[148:151], v6 offset:8192
    ds_read_b128 v[80:83], v4 offset:0
    s_waitcnt lgkmcnt(9)
    v_mfma_f32_16x16x32_bf16 v[20:23], v[116:119], v[152:155], v[20:23]
    v_mfma_f32_16x16x32_bf16 v[52:55], v[116:119], v[156:159], v[52:55]
    ds_read_b128 v[84:87], v4 offset:2048
    s_waitcnt lgkmcnt(9)
    v_mfma_f32_16x16x32_bf16 v[24:27], v[120:123], v[152:155], v[24:27]
    v_mfma_f32_16x16x32_bf16 v[56:59], v[120:123], v[156:159], v[56:59]
    ds_read_b128 v[88:91], v4 offset:4096
    s_waitcnt lgkmcnt(9)
    v_mfma_f32_16x16x32_bf16 v[28:31], v[124:127], v[152:155], v[28:31]
    v_mfma_f32_16x16x32_bf16 v[60:63], v[124:127], v[156:159], v[60:63]
    ds_read_b128 v[92:95], v4 offset:6144
    s_waitcnt lgkmcnt(9)
    v_mfma_f32_16x16x32_bf16 v[32:35], v[128:131], v[152:155], v[32:35]
    v_mfma_f32_16x16x32_bf16 v[64:67], v[128:131], v[156:159], v[64:67]
    ds_read_b128 v[96:99], v4 offset:8192
    s_waitcnt lgkmcnt(9)
    v_mfma_f32_16x16x32_bf16 v[36:39], v[132:135], v[152:155], v[36:39]
    v_mfma_f32_16x16x32_bf16 v[68:71], v[132:135], v[156:159], v[68:71]
    ds_read_b128 v[100:103], v4 offset:10240
    s_waitcnt lgkmcnt(9)
    v_mfma_f32_16x16x32_bf16 v[40:43], v[136:139], v[152:155], v[40:43]
    v_mfma_f32_16x16x32_bf16 v[72:75], v[136:139], v[156:159], v[72:75]
    ds_read_b128 v[104:107], v4 offset:12288
    s_waitcnt lgkmcnt(9)
    v_mfma_f32_16x16x32_bf16 v[44:47], v[140:143], v[152:155], v[44:47]
    v_mfma_f32_16x16x32_bf16 v[76:79], v[140:143], v[156:159], v[76:79]
    ds_read_b128 v[108:111], v4 offset:14336
    s_waitcnt lgkmcnt(7)
    v_mfma_f32_16x16x32_bf16 v[16:19], v[80:83], v[144:147], v[16:19]
    v_mfma_f32_16x16x32_bf16 v[48:51], v[80:83], v[148:151], v[48:51]
    ds_read_b128 v[152:155], v7 offset:0
    ds_read_b128 v[156:159], v7 offset:8192
    ds_read_b128 v[112:115], v5 offset:0
    s_waitcnt lgkmcnt(9)
    v_mfma_f32_16x16x32_bf16 v[20:23], v[84:87], v[144:147], v[20:23]
    v_mfma_f32_16x16x32_bf16 v[52:55], v[84:87], v[148:151], v[52:55]
    ds_read_b128 v[116:119], v5 offset:2048
    s_waitcnt lgkmcnt(9)
    v_mfma_f32_16x16x32_bf16 v[24:27], v[88:91], v[144:147], v[24:27]
    v_mfma_f32_16x16x32_bf16 v[56:59], v[88:91], v[148:151], v[56:59]
    ds_read_b128 v[120:123], v5 offset:4096
    s_waitcnt lgkmcnt(9)
    v_mfma_f32_16x16x32_bf16 v[28:31], v[92:95], v[144:147], v[28:31]
    v_mfma_f32_16x16x32_bf16 v[60:63], v[92:95], v[148:151], v[60:63]
    ds_read_b128 v[124:127], v5 offset:6144
    s_waitcnt lgkmcnt(9)
    v_mfma_f32_16x16x32_bf16 v[32:35], v[96:99], v[144:147], v[32:35]
    v_mfma_f32_16x16x32_bf16 v[64:67], v[96:99], v[148:151], v[64:67]
    ds_read_b128 v[128:131], v5 offset:8192
    s_waitcnt lgkmcnt(9)
    v_mfma_f32_16x16x32_bf16 v[36:39], v[100:103], v[144:147], v[36:39]
    v_mfma_f32_16x16x32_bf16 v[68:71], v[100:103], v[148:151], v[68:71]
    ds_read_b128 v[132:135], v5 offset:10240
    s_waitcnt lgkmcnt(9)
    v_mfma_f32_16x16x32_bf16 v[40:43], v[104:107], v[144:147], v[40:43]
    v_mfma_f32_16x16x32_bf16 v[72:75], v[104:107], v[148:151], v[72:75]
    ds_read_b128 v[136:139], v5 offset:12288
    s_waitcnt lgkmcnt(9)
    v_mfma_f32_16x16x32_bf16 v[44:47], v[108:111], v[144:147], v[44:47]
    v_mfma_f32_16x16x32_bf16 v[76:79], v[108:111], v[148:151], v[76:79]
    ds_read_b128 v[140:143], v5 offset:14336
    s_barrier
    v_add_u32 v4, 0x8000, v4
    v_add_u32 v5, 0x8000, v5
    v_add_u32 v6, 0x8000, v6
    v_add_u32 v7, 0x8000, v7
    s_waitcnt lgkmcnt(7)
    v_mfma_f32_16x16x32_bf16 v[16:19], v[112:115], v[152:155], v[16:19]
    v_mfma_f32_16x16x32_bf16 v[48:51], v[112:115], v[156:159], v[48:51]
    ds_read_b128 v[144:147], v6 offset:0
    ds_read_b128 v[148:151], v6 offset:8192
    ds_read_b128 v[80:83], v4 offset:0
    s_waitcnt lgkmcnt(9)
    v_mfma_f32_16x16x32_bf16 v[20:23], v[116:119], v[152:155], v[20:23]
    v_mfma_f32_16x16x32_bf16 v[52:55], v[116:119], v[156:159], v[52:55]
    ds_read_b128 v[84:87], v4 offset:2048
    s_waitcnt lgkmcnt(9)
    v_mfma_f32_16x16x32_bf16 v[24:27], v[120:123], v[152:155], v[24:27]
    v_mfma_f32_16x16x32_bf16 v[56:59], v[120:123], v[156:159], v[56:59]
    ds_read_b128 v[88:91], v4 offset:4096
    s_waitcnt lgkmcnt(9)
    v_mfma_f32_16x16x32_bf16 v[28:31], v[124:127], v[152:155], v[28:31]
    v_mfma_f32_16x16x32_bf16 v[60:63], v[124:127], v[156:159], v[60:63]
    ds_read_b128 v[92:95], v4 offset:6144
    s_waitcnt lgkmcnt(9)
    v_mfma_f32_16x16x32_bf16 v[32:35], v[128:131], v[152:155], v[32:35]
    v_mfma_f32_16x16x32_bf16 v[64:67], v[128:131], v[156:159], v[64:67]
    ds_read_b128 v[96:99], v4 offset:8192
    s_waitcnt lgkmcnt(9)
    v_mfma_f32_16x16x32_bf16 v[36:39], v[132:135], v[152:155], v[36:39]
    v_mfma_f32_16x16x32_bf16 v[68:71], v[132:135], v[156:159], v[68:71]
    ds_read_b128 v[100:103], v4 offset:10240
    s_waitcnt lgkmcnt(9)
    v_mfma_f32_16x16x32_bf16 v[40:43], v[136:139], v[152:155], v[40:43]
    v_mfma_f32_16x16x32_bf16 v[72:75], v[136:139], v[156:159], v[72:75]
    ds_read_b128 v[104:107], v4 offset:12288
    s_waitcnt lgkmcnt(9)
    v_mfma_f32_16x16x32_bf16 v[44:47], v[140:143], v[152:155], v[44:47]
    v_mfma_f32_16x16x32_bf16 v[76:79], v[140:143], v[156:159], v[76:79]
    ds_read_b128 v[108:111], v4 offset:14336
    s_waitcnt lgkmcnt(7)
    v_mfma_f32_16x16x32_bf16 v[16:19], v[80:83], v[144:147], v[16:19]
    v_mfma_f32_16x16x32_bf16 v[48:51], v[80:83], v[148:151], v[48:51]
    ds_read_b128 v[152:155], v7 offset:0
    ds_read_b128 v[156:159], v7 offset:8192
    ds_read_b128 v[112:115], v5 offset:0
    s_waitcnt lgkmcnt(9)
    v_mfma_f32_16x16x32_bf16 v[20:23], v[84:87], v[144:147], v[20:23]
    v_mfma_f32_16x16x32_bf16 v[52:55], v[84:87], v[148:151], v[52:55]
    ds_read_b128 v[116:119], v5 offset:2048
    s_waitcnt lgkmcnt(9)
    v_mfma_f32_16x16x32_bf16 v[24:27], v[88:91], v[144:147], v[24:27]
    v_mfma_f32_16x16x32_bf16 v[56:59], v[88:91], v[148:151], v[56:59]
    ds_read_b128 v[120:123], v5 offset:4096
    s_waitcnt lgkmcnt(9)
    v_mfma_f32_16x16x32_bf16 v[28:31], v[92:95], v[144:147], v[28:31]
    v_mfma_f32_16x16x32_bf16 v[60:63], v[92:95], v[148:151], v[60:63]
    ds_read_b128 v[124:127], v5 offset:6144
    s_waitcnt lgkmcnt(9)
    v_mfma_f32_16x16x32_bf16 v[32:35], v[96:99], v[144:147], v[32:35]
    v_mfma_f32_16x16x32_bf16 v[64:67], v[96:99], v[148:151], v[64:67]
    ds_read_b128 v[128:131], v5 offset:8192
    s_waitcnt lgkmcnt(9)
    v_mfma_f32_16x16x32_bf16 v[36:39], v[100:103], v[144:147], v[36:39]
    v_mfma_f32_16x16x32_bf16 v[68:71], v[100:103], v[148:151], v[68:71]
    ds_read_b128 v[132:135], v5 offset:10240
    s_waitcnt lgkmcnt(9)
    v_mfma_f32_16x16x32_bf16 v[40:43], v[104:107], v[144:147], v[40:43]
    v_mfma_f32_16x16x32_bf16 v[72:75], v[104:107], v[148:151], v[72:75]
    ds_read_b128 v[136:139], v5 offset:12288
    s_waitcnt lgkmcnt(9)
    v_mfma_f32_16x16x32_bf16 v[44:47], v[108:111], v[144:147], v[44:47]
    v_mfma_f32_16x16x32_bf16 v[76:79], v[108:111], v[148:151], v[76:79]
    ds_read_b128 v[140:143], v5 offset:14336
    s_barrier
    v_add_u32 v4, 0x8000, v4
    v_add_u32 v5, 0x8000, v5
    v_add_u32 v6, 0x8000, v6
    v_add_u32 v7, 0x8000, v7
    s_waitcnt lgkmcnt(7)
    v_mfma_f32_16x16x32_bf16 v[16:19], v[112:115], v[152:155], v[16:19]
    v_mfma_f32_16x16x32_bf16 v[48:51], v[112:115], v[156:159], v[48:51]
    ds_read_b128 v[144:147], v6 offset:0
    ds_read_b128 v[148:151], v6 offset:8192
    ds_read_b128 v[80:83], v4 offset:0
    s_waitcnt lgkmcnt(9)
    v_mfma_f32_16x16x32_bf16 v[20:23], v[116:119], v[152:155], v[20:23]
    v_mfma_f32_16x16x32_bf16 v[52:55], v[116:119], v[156:159], v[52:55]
    ds_read_b128 v[84:87], v4 offset:2048
    s_waitcnt lgkmcnt(9)
    v_mfma_f32_16x16x32_bf16 v[24:27], v[120:123], v[152:155], v[24:27]
    v_mfma_f32_16x16x32_bf16 v[56:59], v[120:123], v[156:159], v[56:59]
    ds_read_b128 v[88:91], v4 offset:4096
    s_waitcnt lgkmcnt(9)
    v_mfma_f32_16x16x32_bf16 v[28:31], v[124:127], v[152:155], v[28:31]
    v_mfma_f32_16x16x32_bf16 v[60:63], v[124:127], v[156:159], v[60:63]
    ds_read_b128 v[92:95], v4 offset:6144
    s_waitcnt lgkmcnt(9)
    v_mfma_f32_16x16x32_bf16 v[32:35], v[128:131], v[152:155], v[32:35]
    v_mfma_f32_16x16x32_bf16 v[64:67], v[128:131], v[156:159], v[64:67]
    ds_read_b128 v[96:99], v4 offset:8192
    s_waitcnt lgkmcnt(9)
    v_mfma_f32_16x16x32_bf16 v[36:39], v[132:135], v[152:155], v[36:39]
    v_mfma_f32_16x16x32_bf16 v[68:71], v[132:135], v[156:159], v[68:71]
    ds_read_b128 v[100:103], v4 offset:10240
    s_waitcnt lgkmcnt(9)
    v_mfma_f32_16x16x32_bf16 v[40:43], v[136:139], v[152:155], v[40:43]
    v_mfma_f32_16x16x32_bf16 v[72:75], v[136:139], v[156:159], v[72:75]
    ds_read_b128 v[104:107], v4 offset:12288
    s_waitcnt lgkmcnt(9)
    v_mfma_f32_16x16x32_bf16 v[44:47], v[140:143], v[152:155], v[44:47]
    v_mfma_f32_16x16x32_bf16 v[76:79], v[140:143], v[156:159], v[76:79]
    ds_read_b128 v[108:111], v4 offset:14336
    s_waitcnt lgkmcnt(7)
    v_mfma_f32_16x16x32_bf16 v[16:19], v[80:83], v[144:147], v[16:19]
    v_mfma_f32_16x16x32_bf16 v[48:51], v[80:83], v[148:151], v[48:51]
    ds_read_b128 v[152:155], v7 offset:0
    ds_read_b128 v[156:159], v7 offset:8192
    ds_read_b128 v[112:115], v5 offset:0
    s_waitcnt lgkmcnt(9)
    v_mfma_f32_16x16x32_bf16 v[20:23], v[84:87], v[144:147], v[20:23]
    v_mfma_f32_16x16x32_bf16 v[52:55], v[84:87], v[148:151], v[52:55]
    ds_read_b128 v[116:119], v5 offset:2048
    s_waitcnt lgkmcnt(9)
    v_mfma_f32_16x16x32_bf16 v[24:27], v[88:91], v[144:147], v[24:27]
    v_mfma_f32_16x16x32_bf16 v[56:59], v[88:91], v[148:151], v[56:59]
    ds_read_b128 v[120:123], v5 offset:4096
    s_waitcnt lgkmcnt(9)
    v_mfma_f32_16x16x32_bf16 v[28:31], v[92:95], v[144:147], v[28:31]
    v_mfma_f32_16x16x32_bf16 v[60:63], v[92:95], v[148:151], v[60:63]
    ds_read_b128 v[124:127], v5 offset:6144
    s_waitcnt lgkmcnt(9)
    v_mfma_f32_16x16x32_bf16 v[32:35], v[96:99], v[144:147], v[32:35]
    v_mfma_f32_16x16x32_bf16 v[64:67], v[96:99], v[148:151], v[64:67]
    ds_read_b128 v[128:131], v5 offset:8192
    s_waitcnt lgkmcnt(9)
    v_mfma_f32_16x16x32_bf16 v[36:39], v[100:103], v[144:147], v[36:39]
    v_mfma_f32_16x16x32_bf16 v[68:71], v[100:103], v[148:151], v[68:71]
    ds_read_b128 v[132:135], v5 offset:10240
    s_waitcnt lgkmcnt(9)
    v_mfma_f32_16x16x32_bf16 v[40:43], v[104:107], v[144:147], v[40:43]
    v_mfma_f32_16x16x32_bf16 v[72:75], v[104:107], v[148:151], v[72:75]
    ds_read_b128 v[136:139], v5 offset:12288
    s_waitcnt lgkmcnt(9)
    v_mfma_f32_16x16x32_bf16 v[44:47], v[108:111], v[144:147], v[44:47]
    v_mfma_f32_16x16x32_bf16 v[76:79], v[108:111], v[148:151], v[76:79]
    ds_read_b128 v[140:143], v5 offset:14336
    s_barrier
    v_add_u32 v4, 0xfffe0000, v4
    v_add_u32 v5, 0xfffe0000, v5
    v_add_u32 v6, 0xfffe0000, v6
    v_add_u32 v7, 0xfffe0000, v7
    s_waitcnt lgkmcnt(7)
    v_mfma_f32_16x16x32_bf16 v[16:19], v[112:115], v[152:155], v[16:19]
    v_mfma_f32_16x16x32_bf16 v[48:51], v[112:115], v[156:159], v[48:51]
    ds_read_b128 v[144:147], v6 offset:0
    ds_read_b128 v[148:151], v6 offset:8192
    ds_read_b128 v[80:83], v4 offset:0
    s_waitcnt lgkmcnt(9)
    v_mfma_f32_16x16x32_bf16 v[20:23], v[116:119], v[152:155], v[20:23]
    v_mfma_f32_16x16x32_bf16 v[52:55], v[116:119], v[156:159], v[52:55]
    ds_read_b128 v[84:87], v4 offset:2048
    s_waitcnt lgkmcnt(9)
    v_mfma_f32_16x16x32_bf16 v[24:27], v[120:123], v[152:155], v[24:27]
    v_mfma_f32_16x16x32_bf16 v[56:59], v[120:123], v[156:159], v[56:59]
    ds_read_b128 v[88:91], v4 offset:4096
    s_waitcnt lgkmcnt(9)
    v_mfma_f32_16x16x32_bf16 v[28:31], v[124:127], v[152:155], v[28:31]
    v_mfma_f32_16x16x32_bf16 v[60:63], v[124:127], v[156:159], v[60:63]
    ds_read_b128 v[92:95], v4 offset:6144
    s_waitcnt lgkmcnt(9)
    v_mfma_f32_16x16x32_bf16 v[32:35], v[128:131], v[152:155], v[32:35]
    v_mfma_f32_16x16x32_bf16 v[64:67], v[128:131], v[156:159], v[64:67]
    ds_read_b128 v[96:99], v4 offset:8192
    s_waitcnt lgkmcnt(9)
    v_mfma_f32_16x16x32_bf16 v[36:39], v[132:135], v[152:155], v[36:39]
    v_mfma_f32_16x16x32_bf16 v[68:71], v[132:135], v[156:159], v[68:71]
    ds_read_b128 v[100:103], v4 offset:10240
    s_waitcnt lgkmcnt(9)
    v_mfma_f32_16x16x32_bf16 v[40:43], v[136:139], v[152:155], v[40:43]
    v_mfma_f32_16x16x32_bf16 v[72:75], v[136:139], v[156:159], v[72:75]
    ds_read_b128 v[104:107], v4 offset:12288
    s_waitcnt lgkmcnt(9)
    v_mfma_f32_16x16x32_bf16 v[44:47], v[140:143], v[152:155], v[44:47]
    v_mfma_f32_16x16x32_bf16 v[76:79], v[140:143], v[156:159], v[76:79]
    ds_read_b128 v[108:111], v4 offset:14336
    s_waitcnt lgkmcnt(7)
    v_mfma_f32_16x16x32_bf16 v[16:19], v[80:83], v[144:147], v[16:19]
    v_mfma_f32_16x16x32_bf16 v[48:51], v[80:83], v[148:151], v[48:51]
    ds_read_b128 v[152:155], v7 offset:0
    ds_read_b128 v[156:159], v7 offset:8192
    ds_read_b128 v[112:115], v5 offset:0
    s_waitcnt lgkmcnt(9)
    v_mfma_f32_16x16x32_bf16 v[20:23], v[84:87], v[144:147], v[20:23]
    v_mfma_f32_16x16x32_bf16 v[52:55], v[84:87], v[148:151], v[52:55]
    ds_read_b128 v[116:119], v5 offset:2048
    s_waitcnt lgkmcnt(9)
    v_mfma_f32_16x16x32_bf16 v[24:27], v[88:91], v[144:147], v[24:27]
    v_mfma_f32_16x16x32_bf16 v[56:59], v[88:91], v[148:151], v[56:59]
    ds_read_b128 v[120:123], v5 offset:4096
    s_waitcnt lgkmcnt(9)
    v_mfma_f32_16x16x32_bf16 v[28:31], v[92:95], v[144:147], v[28:31]
    v_mfma_f32_16x16x32_bf16 v[60:63], v[92:95], v[148:151], v[60:63]
    ds_read_b128 v[124:127], v5 offset:6144
    s_waitcnt lgkmcnt(9)
    v_mfma_f32_16x16x32_bf16 v[32:35], v[96:99], v[144:147], v[32:35]
    v_mfma_f32_16x16x32_bf16 v[64:67], v[96:99], v[148:151], v[64:67]
    ds_read_b128 v[128:131], v5 offset:8192
    s_waitcnt lgkmcnt(9)
    v_mfma_f32_16x16x32_bf16 v[36:39], v[100:103], v[144:147], v[36:39]
    v_mfma_f32_16x16x32_bf16 v[68:71], v[100:103], v[148:151], v[68:71]
    ds_read_b128 v[132:135], v5 offset:10240
    s_waitcnt lgkmcnt(9)
    v_mfma_f32_16x16x32_bf16 v[40:43], v[104:107], v[144:147], v[40:43]
    v_mfma_f32_16x16x32_bf16 v[72:75], v[104:107], v[148:151], v[72:75]
    ds_read_b128 v[136:139], v5 offset:12288
    s_waitcnt lgkmcnt(9)
    v_mfma_f32_16x16x32_bf16 v[44:47], v[108:111], v[144:147], v[44:47]
    v_mfma_f32_16x16x32_bf16 v[76:79], v[108:111], v[148:151], v[76:79]
    ds_read_b128 v[140:143], v5 offset:14336
    s_barrier
    v_add_u32 v4, 0x8000, v4
    v_add_u32 v5, 0x8000, v5
    v_add_u32 v6, 0x8000, v6
    v_add_u32 v7, 0x8000, v7
    s_waitcnt lgkmcnt(7)
    v_mfma_f32_16x16x32_bf16 v[16:19], v[112:115], v[152:155], v[16:19]
    v_mfma_f32_16x16x32_bf16 v[48:51], v[112:115], v[156:159], v[48:51]
    ds_read_b128 v[144:147], v6 offset:0
    ds_read_b128 v[148:151], v6 offset:8192
    ds_read_b128 v[80:83], v4 offset:0
    s_waitcnt lgkmcnt(9)
    v_mfma_f32_16x16x32_bf16 v[20:23], v[116:119], v[152:155], v[20:23]
    v_mfma_f32_16x16x32_bf16 v[52:55], v[116:119], v[156:159], v[52:55]
    ds_read_b128 v[84:87], v4 offset:2048
    s_waitcnt lgkmcnt(9)
    v_mfma_f32_16x16x32_bf16 v[24:27], v[120:123], v[152:155], v[24:27]
    v_mfma_f32_16x16x32_bf16 v[56:59], v[120:123], v[156:159], v[56:59]
    ds_read_b128 v[88:91], v4 offset:4096
    s_waitcnt lgkmcnt(9)
    v_mfma_f32_16x16x32_bf16 v[28:31], v[124:127], v[152:155], v[28:31]
    v_mfma_f32_16x16x32_bf16 v[60:63], v[124:127], v[156:159], v[60:63]
    ds_read_b128 v[92:95], v4 offset:6144
    s_waitcnt lgkmcnt(9)
    v_mfma_f32_16x16x32_bf16 v[32:35], v[128:131], v[152:155], v[32:35]
    v_mfma_f32_16x16x32_bf16 v[64:67], v[128:131], v[156:159], v[64:67]
    ds_read_b128 v[96:99], v4 offset:8192
    s_waitcnt lgkmcnt(9)
    v_mfma_f32_16x16x32_bf16 v[36:39], v[132:135], v[152:155], v[36:39]
    v_mfma_f32_16x16x32_bf16 v[68:71], v[132:135], v[156:159], v[68:71]
    ds_read_b128 v[100:103], v4 offset:10240
    s_waitcnt lgkmcnt(9)
    v_mfma_f32_16x16x32_bf16 v[40:43], v[136:139], v[152:155], v[40:43]
    v_mfma_f32_16x16x32_bf16 v[72:75], v[136:139], v[156:159], v[72:75]
    ds_read_b128 v[104:107], v4 offset:12288
    s_waitcnt lgkmcnt(9)
    v_mfma_f32_16x16x32_bf16 v[44:47], v[140:143], v[152:155], v[44:47]
    v_mfma_f32_16x16x32_bf16 v[76:79], v[140:143], v[156:159], v[76:79]
    ds_read_b128 v[108:111], v4 offset:14336
    s_waitcnt lgkmcnt(7)
    v_mfma_f32_16x16x32_bf16 v[16:19], v[80:83], v[144:147], v[16:19]
    v_mfma_f32_16x16x32_bf16 v[48:51], v[80:83], v[148:151], v[48:51]
    ds_read_b128 v[152:155], v7 offset:0
    ds_read_b128 v[156:159], v7 offset:8192
    ds_read_b128 v[112:115], v5 offset:0
    s_waitcnt lgkmcnt(9)
    v_mfma_f32_16x16x32_bf16 v[20:23], v[84:87], v[144:147], v[20:23]
    v_mfma_f32_16x16x32_bf16 v[52:55], v[84:87], v[148:151], v[52:55]
    ds_read_b128 v[116:119], v5 offset:2048
    s_waitcnt lgkmcnt(9)
    v_mfma_f32_16x16x32_bf16 v[24:27], v[88:91], v[144:147], v[24:27]
    v_mfma_f32_16x16x32_bf16 v[56:59], v[88:91], v[148:151], v[56:59]
    ds_read_b128 v[120:123], v5 offset:4096
    s_waitcnt lgkmcnt(9)
    v_mfma_f32_16x16x32_bf16 v[28:31], v[92:95], v[144:147], v[28:31]
    v_mfma_f32_16x16x32_bf16 v[60:63], v[92:95], v[148:151], v[60:63]
    ds_read_b128 v[124:127], v5 offset:6144
    s_waitcnt lgkmcnt(9)
    v_mfma_f32_16x16x32_bf16 v[32:35], v[96:99], v[144:147], v[32:35]
    v_mfma_f32_16x16x32_bf16 v[64:67], v[96:99], v[148:151], v[64:67]
    ds_read_b128 v[128:131], v5 offset:8192
    s_waitcnt lgkmcnt(9)
    v_mfma_f32_16x16x32_bf16 v[36:39], v[100:103], v[144:147], v[36:39]
    v_mfma_f32_16x16x32_bf16 v[68:71], v[100:103], v[148:151], v[68:71]
    ds_read_b128 v[132:135], v5 offset:10240
    s_waitcnt lgkmcnt(9)
    v_mfma_f32_16x16x32_bf16 v[40:43], v[104:107], v[144:147], v[40:43]
    v_mfma_f32_16x16x32_bf16 v[72:75], v[104:107], v[148:151], v[72:75]
    ds_read_b128 v[136:139], v5 offset:12288
    s_waitcnt lgkmcnt(9)
    v_mfma_f32_16x16x32_bf16 v[44:47], v[108:111], v[144:147], v[44:47]
    v_mfma_f32_16x16x32_bf16 v[76:79], v[108:111], v[148:151], v[76:79]
    ds_read_b128 v[140:143], v5 offset:14336
    s_barrier
    v_add_u32 v4, 0x8000, v4
    v_add_u32 v5, 0x8000, v5
    v_add_u32 v6, 0x8000, v6
    v_add_u32 v7, 0x8000, v7
    s_waitcnt lgkmcnt(7)
    v_mfma_f32_16x16x32_bf16 v[16:19], v[112:115], v[152:155], v[16:19]
    v_mfma_f32_16x16x32_bf16 v[48:51], v[112:115], v[156:159], v[48:51]
    ds_read_b128 v[144:147], v6 offset:0
    ds_read_b128 v[148:151], v6 offset:8192
    ds_read_b128 v[80:83], v4 offset:0
    s_waitcnt lgkmcnt(9)
    v_mfma_f32_16x16x32_bf16 v[20:23], v[116:119], v[152:155], v[20:23]
    v_mfma_f32_16x16x32_bf16 v[52:55], v[116:119], v[156:159], v[52:55]
    ds_read_b128 v[84:87], v4 offset:2048
    s_waitcnt lgkmcnt(9)
    v_mfma_f32_16x16x32_bf16 v[24:27], v[120:123], v[152:155], v[24:27]
    v_mfma_f32_16x16x32_bf16 v[56:59], v[120:123], v[156:159], v[56:59]
    ds_read_b128 v[88:91], v4 offset:4096
    s_waitcnt lgkmcnt(9)
    v_mfma_f32_16x16x32_bf16 v[28:31], v[124:127], v[152:155], v[28:31]
    v_mfma_f32_16x16x32_bf16 v[60:63], v[124:127], v[156:159], v[60:63]
    ds_read_b128 v[92:95], v4 offset:6144
    s_waitcnt lgkmcnt(9)
    v_mfma_f32_16x16x32_bf16 v[32:35], v[128:131], v[152:155], v[32:35]
    v_mfma_f32_16x16x32_bf16 v[64:67], v[128:131], v[156:159], v[64:67]
    ds_read_b128 v[96:99], v4 offset:8192
    s_waitcnt lgkmcnt(9)
    v_mfma_f32_16x16x32_bf16 v[36:39], v[132:135], v[152:155], v[36:39]
    v_mfma_f32_16x16x32_bf16 v[68:71], v[132:135], v[156:159], v[68:71]
    ds_read_b128 v[100:103], v4 offset:10240
    s_waitcnt lgkmcnt(9)
    v_mfma_f32_16x16x32_bf16 v[40:43], v[136:139], v[152:155], v[40:43]
    v_mfma_f32_16x16x32_bf16 v[72:75], v[136:139], v[156:159], v[72:75]
    ds_read_b128 v[104:107], v4 offset:12288
    s_waitcnt lgkmcnt(9)
    v_mfma_f32_16x16x32_bf16 v[44:47], v[140:143], v[152:155], v[44:47]
    v_mfma_f32_16x16x32_bf16 v[76:79], v[140:143], v[156:159], v[76:79]
    ds_read_b128 v[108:111], v4 offset:14336
    s_waitcnt lgkmcnt(7)
    v_mfma_f32_16x16x32_bf16 v[16:19], v[80:83], v[144:147], v[16:19]
    v_mfma_f32_16x16x32_bf16 v[48:51], v[80:83], v[148:151], v[48:51]
    ds_read_b128 v[152:155], v7 offset:0
    ds_read_b128 v[156:159], v7 offset:8192
    ds_read_b128 v[112:115], v5 offset:0
    s_waitcnt lgkmcnt(9)
    v_mfma_f32_16x16x32_bf16 v[20:23], v[84:87], v[144:147], v[20:23]
    v_mfma_f32_16x16x32_bf16 v[52:55], v[84:87], v[148:151], v[52:55]
    ds_read_b128 v[116:119], v5 offset:2048
    s_waitcnt lgkmcnt(9)
    v_mfma_f32_16x16x32_bf16 v[24:27], v[88:91], v[144:147], v[24:27]
    v_mfma_f32_16x16x32_bf16 v[56:59], v[88:91], v[148:151], v[56:59]
    ds_read_b128 v[120:123], v5 offset:4096
    s_waitcnt lgkmcnt(9)
    v_mfma_f32_16x16x32_bf16 v[28:31], v[92:95], v[144:147], v[28:31]
    v_mfma_f32_16x16x32_bf16 v[60:63], v[92:95], v[148:151], v[60:63]
    ds_read_b128 v[124:127], v5 offset:6144
    s_waitcnt lgkmcnt(9)
    v_mfma_f32_16x16x32_bf16 v[32:35], v[96:99], v[144:147], v[32:35]
    v_mfma_f32_16x16x32_bf16 v[64:67], v[96:99], v[148:151], v[64:67]
    ds_read_b128 v[128:131], v5 offset:8192
    s_waitcnt lgkmcnt(9)
    v_mfma_f32_16x16x32_bf16 v[36:39], v[100:103], v[144:147], v[36:39]
    v_mfma_f32_16x16x32_bf16 v[68:71], v[100:103], v[148:151], v[68:71]
    ds_read_b128 v[132:135], v5 offset:10240
    s_waitcnt lgkmcnt(9)
    v_mfma_f32_16x16x32_bf16 v[40:43], v[104:107], v[144:147], v[40:43]
    v_mfma_f32_16x16x32_bf16 v[72:75], v[104:107], v[148:151], v[72:75]
    ds_read_b128 v[136:139], v5 offset:12288
    s_waitcnt lgkmcnt(9)
    v_mfma_f32_16x16x32_bf16 v[44:47], v[108:111], v[144:147], v[44:47]
    v_mfma_f32_16x16x32_bf16 v[76:79], v[108:111], v[148:151], v[76:79]
    ds_read_b128 v[140:143], v5 offset:14336
    s_waitcnt lgkmcnt(7)
    v_mfma_f32_16x16x32_bf16 v[16:19], v[112:115], v[152:155], v[16:19]
    v_mfma_f32_16x16x32_bf16 v[48:51], v[112:115], v[156:159], v[48:51]
    v_mov_b32 v12, 155712
    ds_read_b64 v[230:231], v12
    s_waitcnt lgkmcnt(7)
    v_mfma_f32_16x16x32_bf16 v[20:23], v[116:119], v[152:155], v[20:23]
    v_mfma_f32_16x16x32_bf16 v[52:55], v[116:119], v[156:159], v[52:55]
    s_waitcnt lgkmcnt(6)
    v_mfma_f32_16x16x32_bf16 v[24:27], v[120:123], v[152:155], v[24:27]
    v_mfma_f32_16x16x32_bf16 v[56:59], v[120:123], v[156:159], v[56:59]
    s_waitcnt lgkmcnt(5)
    v_mfma_f32_16x16x32_bf16 v[28:31], v[124:127], v[152:155], v[28:31]
    v_mfma_f32_16x16x32_bf16 v[60:63], v[124:127], v[156:159], v[60:63]
    s_waitcnt lgkmcnt(4)
    v_mfma_f32_16x16x32_bf16 v[32:35], v[128:131], v[152:155], v[32:35]
    v_mfma_f32_16x16x32_bf16 v[64:67], v[128:131], v[156:159], v[64:67]
    s_waitcnt lgkmcnt(3)
    v_mfma_f32_16x16x32_bf16 v[36:39], v[132:135], v[152:155], v[36:39]
    v_mfma_f32_16x16x32_bf16 v[68:71], v[132:135], v[156:159], v[68:71]
    s_waitcnt lgkmcnt(2)
    v_mfma_f32_16x16x32_bf16 v[40:43], v[136:139], v[152:155], v[40:43]
    v_mfma_f32_16x16x32_bf16 v[72:75], v[136:139], v[156:159], v[72:75]
    s_waitcnt lgkmcnt(1)
    v_mfma_f32_16x16x32_bf16 v[44:47], v[140:143], v[152:155], v[44:47]
    v_mfma_f32_16x16x32_bf16 v[76:79], v[140:143], v[156:159], v[76:79]
    s_lshl_b32 s64, s38, 4
    s_add_u32 s64, s64, s37
    s_lshl_b32 s64, s64, 6
    s_lshl_b32 s65, s3, 4
    s_add_u32 s64, s64, s65
    s_lshl_b32 s64, s64, 4
    s_add_u32 s64, s64, 7340032
    v_lshlrev_b32 v13, 4, v10
    v_lshlrev_b32 v12, 2, v10
    v_pk_fma_f32 v[180:181], v[16:17], v[166:167], v[18:19] op_sel_hi:[1,0,1]
    v_pk_fma_f32 v[182:183], v[48:49], v[166:167], v[50:51] op_sel_hi:[1,0,1]
    v_pk_fma_f32 v[180:181], v[48:49], v[166:167], v[180:181] op_sel:[0,1,0] op_sel_hi:[1,1,1] neg_lo:[0,1,0] neg_hi:[0,1,0]
    v_pk_fma_f32 v[182:183], v[16:17], v[166:167], v[182:183] op_sel:[0,1,0] op_sel_hi:[1,1,1]
    v_pk_fma_f32 v[184:185], v[180:181], v[166:167], v[20:21] op_sel_hi:[1,0,1]
    v_pk_fma_f32 v[186:187], v[182:183], v[166:167], v[52:53] op_sel_hi:[1,0,1]
    v_pk_fma_f32 v[184:185], v[182:183], v[166:167], v[184:185] op_sel:[0,1,0] op_sel_hi:[1,1,1] neg_lo:[0,1,0] neg_hi:[0,1,0]
    v_pk_fma_f32 v[186:187], v[180:181], v[166:167], v[186:187] op_sel:[0,1,0] op_sel_hi:[1,1,1]
    v_pk_fma_f32 v[180:181], v[184:185], v[166:167], v[22:23] op_sel_hi:[1,0,1]
    v_pk_fma_f32 v[182:183], v[186:187], v[166:167], v[54:55] op_sel_hi:[1,0,1]
    v_pk_fma_f32 v[180:181], v[186:187], v[166:167], v[180:181] op_sel:[0,1,0] op_sel_hi:[1,1,1] neg_lo:[0,1,0] neg_hi:[0,1,0]
    v_pk_fma_f32 v[182:183], v[184:185], v[166:167], v[182:183] op_sel:[0,1,0] op_sel_hi:[1,1,1]
    v_pk_fma_f32 v[184:185], v[180:181], v[166:167], v[24:25] op_sel_hi:[1,0,1]
    v_pk_fma_f32 v[186:187], v[182:183], v[166:167], v[56:57] op_sel_hi:[1,0,1]
    v_pk_fma_f32 v[184:185], v[182:183], v[166:167], v[184:185] op_sel:[0,1,0] op_sel_hi:[1,1,1] neg_lo:[0,1,0] neg_hi:[0,1,0]
    v_pk_fma_f32 v[186:187], v[180:181], v[166:167], v[186:187] op_sel:[0,1,0] op_sel_hi:[1,1,1]
    v_pk_fma_f32 v[180:181], v[184:185], v[166:167], v[26:27] op_sel_hi:[1,0,1]
    v_pk_fma_f32 v[182:183], v[186:187], v[166:167], v[58:59] op_sel_hi:[1,0,1]
    v_pk_fma_f32 v[180:181], v[186:187], v[166:167], v[180:181] op_sel:[0,1,0] op_sel_hi:[1,1,1] neg_lo:[0,1,0] neg_hi:[0,1,0]
    v_pk_fma_f32 v[182:183], v[184:185], v[166:167], v[182:183] op_sel:[0,1,0] op_sel_hi:[1,1,1]
    v_pk_fma_f32 v[184:185], v[180:181], v[166:167], v[28:29] op_sel_hi:[1,0,1]
    v_pk_fma_f32 v[186:187], v[182:183], v[166:167], v[60:61] op_sel_hi:[1,0,1]
    v_pk_fma_f32 v[184:185], v[182:183], v[166:167], v[184:185] op_sel:[0,1,0] op_sel_hi:[1,1,1] neg_lo:[0,1,0] neg_hi:[0,1,0]
    v_pk_fma_f32 v[186:187], v[180:181], v[166:167], v[186:187] op_sel:[0,1,0] op_sel_hi:[1,1,1]
    v_pk_fma_f32 v[180:181], v[184:185], v[166:167], v[30:31] op_sel_hi:[1,0,1]
    v_pk_fma_f32 v[182:183], v[186:187], v[166:167], v[62:63] op_sel_hi:[1,0,1]
    v_pk_fma_f32 v[180:181], v[186:187], v[166:167], v[180:181] op_sel:[0,1,0] op_sel_hi:[1,1,1] neg_lo:[0,1,0] neg_hi:[0,1,0]
    v_pk_fma_f32 v[182:183], v[184:185], v[166:167], v[182:183] op_sel:[0,1,0] op_sel_hi:[1,1,1]
    v_pk_fma_f32 v[184:185], v[180:181], v[166:167], v[32:33] op_sel_hi:[1,0,1]
    v_pk_fma_f32 v[186:187], v[182:183], v[166:167], v[64:65] op_sel_hi:[1,0,1]
    v_pk_fma_f32 v[184:185], v[182:183], v[166:167], v[184:185] op_sel:[0,1,0] op_sel_hi:[1,1,1] neg_lo:[0,1,0] neg_hi:[0,1,0]
    v_pk_fma_f32 v[186:187], v[180:181], v[166:167], v[186:187] op_sel:[0,1,0] op_sel_hi:[1,1,1]
    v_pk_fma_f32 v[180:181], v[184:185], v[166:167], v[34:35] op_sel_hi:[1,0,1]
    v_pk_fma_f32 v[182:183], v[186:187], v[166:167], v[66:67] op_sel_hi:[1,0,1]
    v_pk_fma_f32 v[180:181], v[186:187], v[166:167], v[180:181] op_sel:[0,1,0] op_sel_hi:[1,1,1] neg_lo:[0,1,0] neg_hi:[0,1,0]
    v_pk_fma_f32 v[182:183], v[184:185], v[166:167], v[182:183] op_sel:[0,1,0] op_sel_hi:[1,1,1]
    v_pk_fma_f32 v[184:185], v[180:181], v[166:167], v[36:37] op_sel_hi:[1,0,1]
    v_pk_fma_f32 v[186:187], v[182:183], v[166:167], v[68:69] op_sel_hi:[1,0,1]
    v_pk_fma_f32 v[184:185], v[182:183], v[166:167], v[184:185] op_sel:[0,1,0] op_sel_hi:[1,1,1] neg_lo:[0,1,0] neg_hi:[0,1,0]
    v_pk_fma_f32 v[186:187], v[180:181], v[166:167], v[186:187] op_sel:[0,1,0] op_sel_hi:[1,1,1]
    v_pk_fma_f32 v[180:181], v[184:185], v[166:167], v[38:39] op_sel_hi:[1,0,1]
    v_pk_fma_f32 v[182:183], v[186:187], v[166:167], v[70:71] op_sel_hi:[1,0,1]
    v_pk_fma_f32 v[180:181], v[186:187], v[166:167], v[180:181] op_sel:[0,1,0] op_sel_hi:[1,1,1] neg_lo:[0,1,0] neg_hi:[0,1,0]
    v_pk_fma_f32 v[182:183], v[184:185], v[166:167], v[182:183] op_sel:[0,1,0] op_sel_hi:[1,1,1]
    v_pk_fma_f32 v[184:185], v[180:181], v[166:167], v[40:41] op_sel_hi:[1,0,1]
    v_pk_fma_f32 v[186:187], v[182:183], v[166:167], v[72:73] op_sel_hi:[1,0,1]
    v_pk_fma_f32 v[184:185], v[182:183], v[166:167], v[184:185] op_sel:[0,1,0] op_sel_hi:[1,1,1] neg_lo:[0,1,0] neg_hi:[0,1,0]
    v_pk_fma_f32 v[186:187], v[180:181], v[166:167], v[186:187] op_sel:[0,1,0] op_sel_hi:[1,1,1]
    v_pk_fma_f32 v[180:181], v[184:185], v[166:167], v[42:43] op_sel_hi:[1,0,1]
    v_pk_fma_f32 v[182:183], v[186:187], v[166:167], v[74:75] op_sel_hi:[1,0,1]
    v_pk_fma_f32 v[180:181], v[186:187], v[166:167], v[180:181] op_sel:[0,1,0] op_sel_hi:[1,1,1] neg_lo:[0,1,0] neg_hi:[0,1,0]
    v_pk_fma_f32 v[182:183], v[184:185], v[166:167], v[182:183] op_sel:[0,1,0] op_sel_hi:[1,1,1]
    v_pk_fma_f32 v[184:185], v[180:181], v[166:167], v[44:45] op_sel_hi:[1,0,1]
    v_pk_fma_f32 v[186:187], v[182:183], v[166:167], v[76:77] op_sel_hi:[1,0,1]
    v_pk_fma_f32 v[184:185], v[182:183], v[166:167], v[184:185] op_sel:[0,1,0] op_sel_hi:[1,1,1] neg_lo:[0,1,0] neg_hi:[0,1,0]
    v_pk_fma_f32 v[186:187], v[180:181], v[166:167], v[186:187] op_sel:[0,1,0] op_sel_hi:[1,1,1]
    v_pk_fma_f32 v[180:181], v[184:185], v[166:167], v[46:47] op_sel_hi:[1,0,1]
    v_pk_fma_f32 v[182:183], v[186:187], v[166:167], v[78:79] op_sel_hi:[1,0,1]
    v_pk_fma_f32 v[180:181], v[186:187], v[166:167], v[180:181] op_sel:[0,1,0] op_sel_hi:[1,1,1] neg_lo:[0,1,0] neg_hi:[0,1,0]
    v_pk_fma_f32 v[182:183], v[184:185], v[166:167], v[182:183] op_sel:[0,1,0] op_sel_hi:[1,1,1]
    v_fma_f32 v188, v168, v180, v181
    v_fma_f32 v189, v168, v182, v183
    v_fma_f32 v188, -v169, v182, v188
    v_fma_f32 v189, v169, v180, v189
    v_add_u32 v14, 0, v12
    ds_bpermute_b32 v190, v14, v188
    ds_bpermute_b32 v191, v14, v189
    v_add_u32 v15, 64, v12
    ds_bpermute_b32 v192, v15, v188
    ds_bpermute_b32 v193, v15, v189
    v_add_u32 v14, 128, v12
    ds_bpermute_b32 v194, v14, v188
    ds_bpermute_b32 v195, v14, v189
    v_add_u32 v15, 192, v12
    ds_bpermute_b32 v196, v15, v188
    ds_bpermute_b32 v197, v15, v189
    s_waitcnt lgkmcnt(0)
    v_fma_f32 v198, v170, v190, v192
    v_fma_f32 v199, v170, v191, v193
    v_fma_f32 v198, -v171, v191, v198
    v_fma_f32 v199, v171, v190, v199
    v_fma_f32 v200, v170, v198, v194
    v_fma_f32 v201, v170, v199, v195
    v_fma_f32 v200, -v171, v199, v200
    v_fma_f32 v201, v171, v198, v201
    v_fma_f32 v228, v170, v200, v196
    v_fma_f32 v229, v170, v201, v197
    v_fma_f32 v228, -v171, v201, v228
    v_fma_f32 v229, v171, v200, v229
    s_mov_b64 s[66:67], exec
    s_mov_b64 exec, 0xffff
    buffer_store_dwordx4 v[228:231], v13, s[48:51], s64 offen sc1
    s_mov_b64 exec, s[66:67]
    s_barrier
    s_lshr_b32 s64, s34, 2
    s_lshl_b32 s68, s37, 7
    s_lshl_b32 s69, s3, 5
    s_add_u32 s68, s68, s69
    s_lshl_b32 s69, s38, 6
    s_lshl_b32 s70, s64, 5
    s_add_u32 s69, s69, s70
    s_mov_b32 s52, s10
    s_and_b32 s53, s11, 0xffff
    s_mov_b32 s54, 0x200000
    s_mov_b32 s55, 0x20000
    s_mov_b32 s56, s26
    s_and_b32 s57, s27, 0xffff
    s_mov_b32 s58, 0x400
    s_mov_b32 s59, 0x20000
    s_lshl_b32 s70, s68, 10
    s_lshl_b32 s71, s69, 1
    s_add_u32 s70, s70, s71
    v_and_b32 v8, 31, v0
    v_lshrrev_b32 v7, 5, v0
    v_lshlrev_b32 v7, 12, v7
    v_lshlrev_b32 v8, 1, v8
    v_add_u32 v7, v7, v8
    buffer_load_ushort v112, v7, s[52:55], s70 offen offset:0
    buffer_load_ushort v113, v7, s[52:55], s70 offen offset:1024
    buffer_load_ushort v114, v7, s[52:55], s70 offen offset:2048
    buffer_load_ushort v115, v7, s[52:55], s70 offen offset:3072
    s_add_u32 s70, s70, 8192
    buffer_load_ushort v116, v7, s[52:55], s70 offen offset:0
    buffer_load_ushort v117, v7, s[52:55], s70 offen offset:1024
    buffer_load_ushort v118, v7, s[52:55], s70 offen offset:2048
    buffer_load_ushort v119, v7, s[52:55], s70 offen offset:3072
    s_add_u32 s70, s70, 8192
    buffer_load_ushort v120, v7, s[52:55], s70 offen offset:0
    buffer_load_ushort v121, v7, s[52:55], s70 offen offset:1024
    buffer_load_ushort v122, v7, s[52:55], s70 offen offset:2048
    buffer_load_ushort v123, v7, s[52:55], s70 offen offset:3072
    s_add_u32 s70, s70, 8192
    buffer_load_ushort v124, v7, s[52:55], s70 offen offset:0
    buffer_load_ushort v125, v7, s[52:55], s70 offen offset:1024
    buffer_load_ushort v126, v7, s[52:55], s70 offen offset:2048
    buffer_load_ushort v127, v7, s[52:55], s70 offen offset:3072
    buffer_load_ushort v239, v8, s[56:59], s71 offen
    s_add_u32 s69, s37, 16
    s_lshl_b32 s69, s69, 7
    s_add_u32 s69, s69, 7733248
    v_and_b32 v228, 7, v0
    v_lshlrev_b32 v228, 4, v228
    v_add_u32 v228, s69, v228
    buffer_load_dwordx4 v[224:227], v228, s[48:51], 0 offen sc1
    v_pk_mul_f32 v[232:233], v[48:49], v[164:165] op_sel:[0,1] op_sel_hi:[1,1]
    v_pk_mul_f32 v[234:235], v[16:17], v[164:165] op_sel:[0,1] op_sel_hi:[1,1]
    v_pk_fma_f32 v[16:17], v[16:17], v[164:165], v[232:233] op_sel_hi:[1,0,1] neg_lo:[0,0,1] neg_hi:[0,0,1]
    v_pk_fma_f32 v[48:49], v[48:49], v[164:165], v[234:235] op_sel_hi:[1,0,1]
    v_pk_mul_f32 v[232:233], v[50:51], v[164:165] op_sel:[0,1] op_sel_hi:[1,1]
    v_pk_mul_f32 v[234:235], v[18:19], v[164:165] op_sel:[0,1] op_sel_hi:[1,1]
    v_pk_fma_f32 v[18:19], v[18:19], v[164:165], v[232:233] op_sel_hi:[1,0,1] neg_lo:[0,0,1] neg_hi:[0,0,1]
    v_pk_fma_f32 v[50:51], v[50:51], v[164:165], v[234:235] op_sel_hi:[1,0,1]
    v_pk_mul_f32 v[232:233], v[52:53], v[164:165] op_sel:[0,1] op_sel_hi:[1,1]
    v_pk_mul_f32 v[234:235], v[20:21], v[164:165] op_sel:[0,1] op_sel_hi:[1,1]
    v_pk_fma_f32 v[20:21], v[20:21], v[164:165], v[232:233] op_sel_hi:[1,0,1] neg_lo:[0,0,1] neg_hi:[0,0,1]
    v_pk_fma_f32 v[52:53], v[52:53], v[164:165], v[234:235] op_sel_hi:[1,0,1]
    v_pk_mul_f32 v[232:233], v[54:55], v[164:165] op_sel:[0,1] op_sel_hi:[1,1]
    v_pk_mul_f32 v[234:235], v[22:23], v[164:165] op_sel:[0,1] op_sel_hi:[1,1]
    v_pk_fma_f32 v[22:23], v[22:23], v[164:165], v[232:233] op_sel_hi:[1,0,1] neg_lo:[0,0,1] neg_hi:[0,0,1]
    v_pk_fma_f32 v[54:55], v[54:55], v[164:165], v[234:235] op_sel_hi:[1,0,1]
    v_pk_mul_f32 v[232:233], v[56:57], v[164:165] op_sel:[0,1] op_sel_hi:[1,1]
    v_pk_mul_f32 v[234:235], v[24:25], v[164:165] op_sel:[0,1] op_sel_hi:[1,1]
    v_pk_fma_f32 v[24:25], v[24:25], v[164:165], v[232:233] op_sel_hi:[1,0,1] neg_lo:[0,0,1] neg_hi:[0,0,1]
    v_pk_fma_f32 v[56:57], v[56:57], v[164:165], v[234:235] op_sel_hi:[1,0,1]
    v_pk_mul_f32 v[232:233], v[58:59], v[164:165] op_sel:[0,1] op_sel_hi:[1,1]
    v_pk_mul_f32 v[234:235], v[26:27], v[164:165] op_sel:[0,1] op_sel_hi:[1,1]
    v_pk_fma_f32 v[26:27], v[26:27], v[164:165], v[232:233] op_sel_hi:[1,0,1] neg_lo:[0,0,1] neg_hi:[0,0,1]
    v_pk_fma_f32 v[58:59], v[58:59], v[164:165], v[234:235] op_sel_hi:[1,0,1]
    v_pk_mul_f32 v[232:233], v[60:61], v[164:165] op_sel:[0,1] op_sel_hi:[1,1]
    v_pk_mul_f32 v[234:235], v[28:29], v[164:165] op_sel:[0,1] op_sel_hi:[1,1]
    v_pk_fma_f32 v[28:29], v[28:29], v[164:165], v[232:233] op_sel_hi:[1,0,1] neg_lo:[0,0,1] neg_hi:[0,0,1]
    v_pk_fma_f32 v[60:61], v[60:61], v[164:165], v[234:235] op_sel_hi:[1,0,1]
    v_pk_mul_f32 v[232:233], v[62:63], v[164:165] op_sel:[0,1] op_sel_hi:[1,1]
    v_pk_mul_f32 v[234:235], v[30:31], v[164:165] op_sel:[0,1] op_sel_hi:[1,1]
    v_pk_fma_f32 v[30:31], v[30:31], v[164:165], v[232:233] op_sel_hi:[1,0,1] neg_lo:[0,0,1] neg_hi:[0,0,1]
    v_pk_fma_f32 v[62:63], v[62:63], v[164:165], v[234:235] op_sel_hi:[1,0,1]
    v_pk_mul_f32 v[232:233], v[64:65], v[164:165] op_sel:[0,1] op_sel_hi:[1,1]
    v_pk_mul_f32 v[234:235], v[32:33], v[164:165] op_sel:[0,1] op_sel_hi:[1,1]
    v_pk_fma_f32 v[32:33], v[32:33], v[164:165], v[232:233] op_sel_hi:[1,0,1] neg_lo:[0,0,1] neg_hi:[0,0,1]
    v_pk_fma_f32 v[64:65], v[64:65], v[164:165], v[234:235] op_sel_hi:[1,0,1]
    v_pk_mul_f32 v[232:233], v[66:67], v[164:165] op_sel:[0,1] op_sel_hi:[1,1]
    v_pk_mul_f32 v[234:235], v[34:35], v[164:165] op_sel:[0,1] op_sel_hi:[1,1]
    v_pk_fma_f32 v[34:35], v[34:35], v[164:165], v[232:233] op_sel_hi:[1,0,1] neg_lo:[0,0,1] neg_hi:[0,0,1]
    v_pk_fma_f32 v[66:67], v[66:67], v[164:165], v[234:235] op_sel_hi:[1,0,1]
    v_pk_mul_f32 v[232:233], v[68:69], v[164:165] op_sel:[0,1] op_sel_hi:[1,1]
    v_pk_mul_f32 v[234:235], v[36:37], v[164:165] op_sel:[0,1] op_sel_hi:[1,1]
    v_pk_fma_f32 v[36:37], v[36:37], v[164:165], v[232:233] op_sel_hi:[1,0,1] neg_lo:[0,0,1] neg_hi:[0,0,1]
    v_pk_fma_f32 v[68:69], v[68:69], v[164:165], v[234:235] op_sel_hi:[1,0,1]
    v_pk_mul_f32 v[232:233], v[70:71], v[164:165] op_sel:[0,1] op_sel_hi:[1,1]
    v_pk_mul_f32 v[234:235], v[38:39], v[164:165] op_sel:[0,1] op_sel_hi:[1,1]
    v_pk_fma_f32 v[38:39], v[38:39], v[164:165], v[232:233] op_sel_hi:[1,0,1] neg_lo:[0,0,1] neg_hi:[0,0,1]
    v_pk_fma_f32 v[70:71], v[70:71], v[164:165], v[234:235] op_sel_hi:[1,0,1]
    v_pk_mul_f32 v[232:233], v[72:73], v[164:165] op_sel:[0,1] op_sel_hi:[1,1]
    v_pk_mul_f32 v[234:235], v[40:41], v[164:165] op_sel:[0,1] op_sel_hi:[1,1]
    v_pk_fma_f32 v[40:41], v[40:41], v[164:165], v[232:233] op_sel_hi:[1,0,1] neg_lo:[0,0,1] neg_hi:[0,0,1]
    v_pk_fma_f32 v[72:73], v[72:73], v[164:165], v[234:235] op_sel_hi:[1,0,1]
    v_pk_mul_f32 v[232:233], v[74:75], v[164:165] op_sel:[0,1] op_sel_hi:[1,1]
    v_pk_mul_f32 v[234:235], v[42:43], v[164:165] op_sel:[0,1] op_sel_hi:[1,1]
    v_pk_fma_f32 v[42:43], v[42:43], v[164:165], v[232:233] op_sel_hi:[1,0,1] neg_lo:[0,0,1] neg_hi:[0,0,1]
    v_pk_fma_f32 v[74:75], v[74:75], v[164:165], v[234:235] op_sel_hi:[1,0,1]
    v_pk_mul_f32 v[232:233], v[76:77], v[164:165] op_sel:[0,1] op_sel_hi:[1,1]
    v_pk_mul_f32 v[234:235], v[44:45], v[164:165] op_sel:[0,1] op_sel_hi:[1,1]
    v_pk_fma_f32 v[44:45], v[44:45], v[164:165], v[232:233] op_sel_hi:[1,0,1] neg_lo:[0,0,1] neg_hi:[0,0,1]
    v_pk_fma_f32 v[76:77], v[76:77], v[164:165], v[234:235] op_sel_hi:[1,0,1]
    v_pk_mul_f32 v[232:233], v[78:79], v[164:165] op_sel:[0,1] op_sel_hi:[1,1]
    v_pk_mul_f32 v[234:235], v[46:47], v[164:165] op_sel:[0,1] op_sel_hi:[1,1]
    v_pk_fma_f32 v[46:47], v[46:47], v[164:165], v[232:233] op_sel_hi:[1,0,1] neg_lo:[0,0,1] neg_hi:[0,0,1]
    v_pk_fma_f32 v[78:79], v[78:79], v[164:165], v[234:235] op_sel_hi:[1,0,1]
    s_waitcnt vmcnt(0)
    v_lshlrev_b32 v239, 16, v239
    v_lshlrev_b32 v112, 16, v112
    v_lshlrev_b32 v113, 16, v113
    v_lshlrev_b32 v114, 16, v114
    v_lshlrev_b32 v115, 16, v115
    v_lshlrev_b32 v116, 16, v116
    v_lshlrev_b32 v117, 16, v117
    v_lshlrev_b32 v118, 16, v118
    v_lshlrev_b32 v119, 16, v119
    v_lshlrev_b32 v120, 16, v120
    v_lshlrev_b32 v121, 16, v121
    v_lshlrev_b32 v122, 16, v122
    v_lshlrev_b32 v123, 16, v123
    v_lshlrev_b32 v124, 16, v124
    v_lshlrev_b32 v125, 16, v125
    v_lshlrev_b32 v126, 16, v126
    v_lshlrev_b32 v127, 16, v127
    v_mul_f32 v112, v112, v239
    v_mul_f32 v113, v113, v239
    v_mul_f32 v114, v114, v239
    v_mul_f32 v115, v115, v239
    v_mul_f32 v116, v116, v239
    v_mul_f32 v117, v117, v239
    v_mul_f32 v118, v118, v239
    v_mul_f32 v119, v119, v239
    v_mul_f32 v120, v120, v239
    v_mul_f32 v121, v121, v239
    v_mul_f32 v122, v122, v239
    v_mul_f32 v123, v123, v239
    v_mul_f32 v124, v124, v239
    v_mul_f32 v125, v125, v239
    v_mul_f32 v126, v126, v239
    v_mul_f32 v127, v127, v239
    v_cvt_pk_bf16_f32 v112, v112, v113
    v_cvt_pk_bf16_f32 v114, v114, v115
    v_cvt_pk_bf16_f32 v116, v116, v117
    v_cvt_pk_bf16_f32 v118, v118, v119
    v_cvt_pk_bf16_f32 v120, v120, v121
    v_cvt_pk_bf16_f32 v122, v122, v123
    v_cvt_pk_bf16_f32 v124, v124, v125
    v_cvt_pk_bf16_f32 v126, v126, v127
    v_and_b32 v113, 0xffff0000, v112
    v_lshlrev_b32 v112, 16, v112
    v_and_b32 v115, 0xffff0000, v114
    v_lshlrev_b32 v114, 16, v114
    v_and_b32 v117, 0xffff0000, v116
    v_lshlrev_b32 v116, 16, v116
    v_and_b32 v119, 0xffff0000, v118
    v_lshlrev_b32 v118, 16, v118
    v_and_b32 v121, 0xffff0000, v120
    v_lshlrev_b32 v120, 16, v120
    v_and_b32 v123, 0xffff0000, v122
    v_lshlrev_b32 v122, 16, v122
    v_and_b32 v125, 0xffff0000, v124
    v_lshlrev_b32 v124, 16, v124
    v_and_b32 v127, 0xffff0000, v126
    v_lshlrev_b32 v126, 16, v126
    v_mov_b32 v128, v112
    v_mov_b32 v144, 0
    v_mov_b32 v129, v113
    v_mov_b32 v145, 0
    v_mov_b32 v130, v114
    v_mov_b32 v146, 0
    v_mov_b32 v131, v115
    v_mov_b32 v147, 0
    v_mov_b32 v132, v116
    v_mov_b32 v148, 0
    v_mov_b32 v133, v117
    v_mov_b32 v149, 0
    v_mov_b32 v134, v118
    v_mov_b32 v150, 0
    v_mov_b32 v135, v119
    v_mov_b32 v151, 0
    v_mov_b32 v136, v120
    v_mov_b32 v152, 0
    v_mov_b32 v137, v121
    v_mov_b32 v153, 0
    v_mov_b32 v138, v122
    v_mov_b32 v154, 0
    v_mov_b32 v139, v123
    v_mov_b32 v155, 0
    v_mov_b32 v140, v124
    v_mov_b32 v156, 0
    v_mov_b32 v141, v125
    v_mov_b32 v157, 0
    v_mov_b32 v142, v126
    v_mov_b32 v158, 0
    v_mov_b32 v143, v127
    v_mov_b32 v159, 0
    s_lshl_b32 s64, s38, 10
    s_lshl_b32 s65, s3, 4
    s_add_u32 s64, s64, s65
    s_lshl_b32 s64, s64, 4
    s_add_u32 s64, s64, 7340032
    v_lshlrev_b32 v13, 4, v10
    v_lshlrev_b32 v14, 10, v11
    v_add_u32 v14, v14, v13
    s_cmp_eq_u32 s37, 0
    s_cbranch_scc1 concat_heads__linear_attn_block__ssm_conv_s5__prompt_kernel_e_zero
    v_add_u32 v15, 0, v11
    v_cmp_gt_u32 s[52:53], s37, v15
    v_add_u32 v15, 4, v11
    v_cmp_gt_u32 s[54:55], s37, v15
    v_add_u32 v15, 8, v11
    v_cmp_gt_u32 s[56:57], s37, v15
    v_add_u32 v15, 12, v11
    v_cmp_gt_u32 s[58:59], s37, v15
    s_mov_b32 s72, 262144
concat_heads__linear_attn_block__ssm_conv_s5__prompt_kernel_e_poll:
    s_mov_b32 s65, s64
    s_cmp_le_u32 s37, 0
    s_cbranch_scc1 concat_heads__linear_attn_block__ssm_conv_s5__prompt_kernel_e_gd
    buffer_load_dwordx4 v[80:83], v14, s[48:51], s65 offen sc1
    s_add_u32 s65, s65, 4096
    s_cmp_le_u32 s37, 4
    s_cbranch_scc1 concat_heads__linear_attn_block__ssm_conv_s5__prompt_kernel_e_gd
    buffer_load_dwordx4 v[84:87], v14, s[48:51], s65 offen sc1
    s_add_u32 s65, s65, 4096
    s_cmp_le_u32 s37, 8
    s_cbranch_scc1 concat_heads__linear_attn_block__ssm_conv_s5__prompt_kernel_e_gd
    buffer_load_dwordx4 v[88:91], v14, s[48:51], s65 offen sc1
    s_add_u32 s65, s65, 4096
    s_cmp_le_u32 s37, 12
    s_cbranch_scc1 concat_heads__linear_attn_block__ssm_conv_s5__prompt_kernel_e_gd
    buffer_load_dwordx4 v[92:95], v14, s[48:51], s65 offen sc1
concat_heads__linear_attn_block__ssm_conv_s5__prompt_kernel_e_gd:
    v_mov_b32 v236, 0
    s_waitcnt vmcnt(0)
    s_cmp_le_u32 s37, 0
    s_cbranch_scc1 concat_heads__linear_attn_block__ssm_conv_s5__prompt_kernel_e_td
    v_xor_b32 v237, v230, v82
    v_xor_b32 v238, v231, v83
    v_or_b32 v237, v237, v238
    v_cndmask_b32 v237, 0, v237, s[52:53]
    v_or_b32 v236, v236, v237
    s_cmp_le_u32 s37, 4
    s_cbranch_scc1 concat_heads__linear_attn_block__ssm_conv_s5__prompt_kernel_e_td
    v_xor_b32 v237, v230, v86
    v_xor_b32 v238, v231, v87
    v_or_b32 v237, v237, v238
    v_cndmask_b32 v237, 0, v237, s[54:55]
    v_or_b32 v236, v236, v237
    s_cmp_le_u32 s37, 8
    s_cbranch_scc1 concat_heads__linear_attn_block__ssm_conv_s5__prompt_kernel_e_td
    v_xor_b32 v237, v230, v90
    v_xor_b32 v238, v231, v91
    v_or_b32 v237, v237, v238
    v_cndmask_b32 v237, 0, v237, s[56:57]
    v_or_b32 v236, v236, v237
    s_cmp_le_u32 s37, 12
    s_cbranch_scc1 concat_heads__linear_attn_block__ssm_conv_s5__prompt_kernel_e_td
    v_xor_b32 v237, v230, v94
    v_xor_b32 v238, v231, v95
    v_or_b32 v237, v237, v238
    v_cndmask_b32 v237, 0, v237, s[58:59]
    v_or_b32 v236, v236, v237
concat_heads__linear_attn_block__ssm_conv_s5__prompt_kernel_e_td:
    v_cmp_ne_u32 vcc, 0, v236
    s_sub_u32 s72, s72, 1
    s_cbranch_scc1 concat_heads__linear_attn_block__ssm_conv_s5__prompt_kernel_e_ok
    s_cbranch_vccnz concat_heads__linear_attn_block__ssm_conv_s5__prompt_kernel_e_poll
concat_heads__linear_attn_block__ssm_conv_s5__prompt_kernel_e_ok:
    v_mov_b32 v204, 0
    v_mov_b32 v205, 0
    v_fma_f32 v206, v218, v204, v80
    v_fma_f32 v207, v218, v205, v81
    v_fma_f32 v206, -v219, v205, v206
    v_fma_f32 v207, v219, v204, v207
    v_cndmask_b32 v204, v204, v206, s[52:53]
    v_cndmask_b32 v205, v205, v207, s[52:53]
    v_fma_f32 v206, v218, v204, v84
    v_fma_f32 v207, v218, v205, v85
    v_fma_f32 v206, -v219, v205, v206
    v_fma_f32 v207, v219, v204, v207
    v_cndmask_b32 v204, v204, v206, s[54:55]
    v_cndmask_b32 v205, v205, v207, s[54:55]
    v_fma_f32 v206, v218, v204, v88
    v_fma_f32 v207, v218, v205, v89
    v_fma_f32 v206, -v219, v205, v206
    v_fma_f32 v207, v219, v204, v207
    v_cndmask_b32 v204, v204, v206, s[56:57]
    v_cndmask_b32 v205, v205, v207, s[56:57]
    v_fma_f32 v206, v218, v204, v92
    v_fma_f32 v207, v218, v205, v93
    v_fma_f32 v206, -v219, v205, v206
    v_fma_f32 v207, v219, v204, v207
    v_cndmask_b32 v204, v204, v206, s[58:59]
    v_cndmask_b32 v205, v205, v207, s[58:59]
    s_sub_u32 s65, s37, 1
    v_sub_u32 v15, s65, v11
    v_and_b32 v15, 3, v15
    v_mov_b32 v206, 1.0
    v_mov_b32 v207, 0
    v_cmp_eq_u32 vcc, 1, v15
    s_nop 1
    v_cndmask_b32 v206, v206, v172, vcc
    v_cndmask_b32 v207, v207, v173, vcc
    v_cmp_eq_u32 vcc, 2, v15
    s_nop 1
    v_cndmask_b32 v206, v206, v214, vcc
    v_cndmask_b32 v207, v207, v215, vcc
    v_cmp_eq_u32 vcc, 3, v15
    s_nop 1
    v_cndmask_b32 v206, v206, v216, vcc
    v_cndmask_b32 v207, v207, v217, vcc
    v_mul_f32 v236, v204, v206
    v_mul_f32 v237, v204, v207
    v_fma_f32 v236, -v205, v207, v236
    v_fma_f32 v237, v205, v206, v237
    v_mov_b32 v238, v236
    v_mov_b32 v206, v237
    s_nop 1
    v_permlane32_swap_b32 v236, v238
    v_permlane32_swap_b32 v237, v206
    s_nop 1
    v_add_f32 v236, v236, v238
    v_add_f32 v237, v237, v206
    v_mov_b32 v238, v236
    v_mov_b32 v206, v237
    s_nop 1
    v_permlane16_swap_b32 v236, v238
    v_permlane16_swap_b32 v237, v206
    s_nop 1
    v_add_f32 v204, v236, v238
    v_add_f32 v205, v237, v206
    s_branch concat_heads__linear_attn_block__ssm_conv_s5__prompt_kernel_e_done
concat_heads__linear_attn_block__ssm_conv_s5__prompt_kernel_e_zero:
    v_mov_b32 v204, 0
    v_mov_b32 v205, 0
    s_waitcnt vmcnt(0)
concat_heads__linear_attn_block__ssm_conv_s5__prompt_kernel_e_done:
    v_readfirstlane_b32 s78, v230
    v_readfirstlane_b32 s79, v231
    s_nop 1
    s_mov_b32 s72, 262144
    s_mov_b32 s73, 0
concat_heads__linear_attn_block__ssm_conv_s5__prompt_kernel_mode_lp_bc:
    v_xor_b32 v224, s78, v224
    v_xor_b32 v225, s79, v225
    v_or_b32 v224, v224, v225
    v_cmp_ne_u32 vcc, 0, v224
    s_cbranch_vccz concat_heads__linear_attn_block__ssm_conv_s5__prompt_kernel_mode_ok_bc
    s_sub_u32 s72, s72, 1
    s_cbranch_scc1 concat_heads__linear_attn_block__ssm_conv_s5__prompt_kernel_mode_to_bc
    buffer_load_dwordx4 v[224:227], v228, s[48:51], 0 offen sc1
    s_waitcnt vmcnt(0)
    s_branch concat_heads__linear_attn_block__ssm_conv_s5__prompt_kernel_mode_lp_bc
concat_heads__linear_attn_block__ssm_conv_s5__prompt_kernel_mode_ok_bc:
    s_getreg_b32 s70, hwreg(HW_REG_XCC_ID, 0, 4)
    v_cmp_ne_u32 vcc, s70, v226
    s_cmp_eq_u64 vcc, 0
    s_cselect_b32 s73, 1, 0
concat_heads__linear_attn_block__ssm_conv_s5__prompt_kernel_mode_to_bc:
    v_fma_f32 v198, v170, v204, v190
    v_fma_f32 v199, v170, v205, v191
    v_fma_f32 v198, -v171, v205, v198
    v_fma_f32 v199, v171, v204, v199
    v_fma_f32 v200, v170, v198, v192
    v_fma_f32 v201, v170, v199, v193
    v_fma_f32 v200, -v171, v199, v200
    v_fma_f32 v201, v171, v198, v201
    v_fma_f32 v202, v170, v200, v194
    v_fma_f32 v203, v170, v201, v195
    v_fma_f32 v202, -v171, v201, v202
    v_fma_f32 v203, v171, v200, v203
    v_cmp_eq_u32 vcc, 1, v11
    s_nop 1
    v_cndmask_b32 v204, v204, v198, vcc
    v_cndmask_b32 v205, v205, v199, vcc
    v_cmp_eq_u32 vcc, 2, v11
    s_nop 1
    v_cndmask_b32 v204, v204, v200, vcc
    v_cndmask_b32 v205, v205, v201, vcc
    v_cmp_eq_u32 vcc, 3, v11
    s_nop 1
    v_cndmask_b32 v204, v204, v202, vcc
    v_cndmask_b32 v205, v205, v203, vcc
    v_fma_f32 v206, v168, v204, v180
    v_fma_f32 v207, v168, v205, v182
    v_fma_f32 v206, -v169, v205, v206
    v_fma_f32 v207, v169, v204, v207
    v_mul_f32 v208, v204, v164
    v_mul_f32 v210, v204, v165
    v_fma_f32 v208, -v205, v165, v208
    v_fma_f32 v210, v205, v164, v210
    v_mul_f32 v209, v206, v164
    v_mul_f32 v211, v206, v165
    v_fma_f32 v209, -v207, v165, v209
    v_fma_f32 v211, v207, v164, v211
    s_lshl_b32 s64, s3, 13
    s_add_u32 s64, s64, 131072
    v_lshlrev_b32 v12, 6, v11
    v_lshlrev_b32 v13, 4, v10
    v_xor_b32 v12, v12, v13
    v_lshlrev_b32 v13, 8, v10
    v_add_u32 v12, v12, v13
    v_add_u32 v12, s64, v12
    v_xor_b32 v213, 16, v12
    v_xor_b32 v214, 32, v12
    v_xor_b32 v215, 48, v12
    v_bfe_u32 v13, v0, 4, 1
    v_lshlrev_b32 v13, 5, v13
    v_and_b32 v14, 3, v0
    v_lshlrev_b32 v14, 3, v14
    v_add_u32 v13, v13, v14
    v_bfe_u32 v14, v0, 2, 2
    v_lshlrev_b32 v15, 4, v14
    v_xor_b32 v13, v13, v15
    v_lshlrev_b32 v14, 8, v14
    v_add_u32 v13, v13, v14
    v_lshrrev_b32 v14, 5, v0
    v_lshlrev_b32 v14, 12, v14
    v_add_u32 v13, v13, v14
    v_add_u32 v13, s64, v13
    v_pk_fma_f32 v[16:17], v[208:209], v[166:167], v[16:17] op_sel_hi:[1,0,1]
    v_pk_fma_f32 v[48:49], v[210:211], v[166:167], v[48:49] op_sel_hi:[1,0,1]
    v_pk_fma_f32 v[16:17], v[210:211], v[166:167], v[16:17] op_sel:[0,1,0] op_sel_hi:[1,1,1] neg_lo:[0,1,0] neg_hi:[0,1,0]
    v_pk_fma_f32 v[48:49], v[208:209], v[166:167], v[48:49] op_sel:[0,1,0] op_sel_hi:[1,1,1]
    v_pk_fma_f32 v[18:19], v[16:17], v[166:167], v[18:19] op_sel_hi:[1,0,1]
    v_pk_fma_f32 v[50:51], v[48:49], v[166:167], v[50:51] op_sel_hi:[1,0,1]
    v_pk_fma_f32 v[18:19], v[48:49], v[166:167], v[18:19] op_sel:[0,1,0] op_sel_hi:[1,1,1] neg_lo:[0,1,0] neg_hi:[0,1,0]
    v_pk_fma_f32 v[50:51], v[16:17], v[166:167], v[50:51] op_sel:[0,1,0] op_sel_hi:[1,1,1]
    v_pk_fma_f32 v[20:21], v[18:19], v[166:167], v[20:21] op_sel_hi:[1,0,1]
    v_pk_fma_f32 v[52:53], v[50:51], v[166:167], v[52:53] op_sel_hi:[1,0,1]
    v_pk_fma_f32 v[20:21], v[50:51], v[166:167], v[20:21] op_sel:[0,1,0] op_sel_hi:[1,1,1] neg_lo:[0,1,0] neg_hi:[0,1,0]
    v_pk_fma_f32 v[52:53], v[18:19], v[166:167], v[52:53] op_sel:[0,1,0] op_sel_hi:[1,1,1]
    v_pk_fma_f32 v[22:23], v[20:21], v[166:167], v[22:23] op_sel_hi:[1,0,1]
    v_pk_fma_f32 v[54:55], v[52:53], v[166:167], v[54:55] op_sel_hi:[1,0,1]
    v_pk_fma_f32 v[22:23], v[52:53], v[166:167], v[22:23] op_sel:[0,1,0] op_sel_hi:[1,1,1] neg_lo:[0,1,0] neg_hi:[0,1,0]
    v_pk_fma_f32 v[54:55], v[20:21], v[166:167], v[54:55] op_sel:[0,1,0] op_sel_hi:[1,1,1]
    v_pk_fma_f32 v[24:25], v[22:23], v[166:167], v[24:25] op_sel_hi:[1,0,1]
    v_pk_fma_f32 v[56:57], v[54:55], v[166:167], v[56:57] op_sel_hi:[1,0,1]
    v_pk_fma_f32 v[24:25], v[54:55], v[166:167], v[24:25] op_sel:[0,1,0] op_sel_hi:[1,1,1] neg_lo:[0,1,0] neg_hi:[0,1,0]
    v_pk_fma_f32 v[56:57], v[22:23], v[166:167], v[56:57] op_sel:[0,1,0] op_sel_hi:[1,1,1]
    v_pk_fma_f32 v[26:27], v[24:25], v[166:167], v[26:27] op_sel_hi:[1,0,1]
    v_pk_fma_f32 v[58:59], v[56:57], v[166:167], v[58:59] op_sel_hi:[1,0,1]
    v_pk_fma_f32 v[26:27], v[56:57], v[166:167], v[26:27] op_sel:[0,1,0] op_sel_hi:[1,1,1] neg_lo:[0,1,0] neg_hi:[0,1,0]
    v_pk_fma_f32 v[58:59], v[24:25], v[166:167], v[58:59] op_sel:[0,1,0] op_sel_hi:[1,1,1]
    v_pk_fma_f32 v[28:29], v[26:27], v[166:167], v[28:29] op_sel_hi:[1,0,1]
    v_pk_fma_f32 v[60:61], v[58:59], v[166:167], v[60:61] op_sel_hi:[1,0,1]
    v_pk_fma_f32 v[28:29], v[58:59], v[166:167], v[28:29] op_sel:[0,1,0] op_sel_hi:[1,1,1] neg_lo:[0,1,0] neg_hi:[0,1,0]
    v_pk_fma_f32 v[60:61], v[26:27], v[166:167], v[60:61] op_sel:[0,1,0] op_sel_hi:[1,1,1]
    v_pk_fma_f32 v[30:31], v[28:29], v[166:167], v[30:31] op_sel_hi:[1,0,1]
    v_pk_fma_f32 v[62:63], v[60:61], v[166:167], v[62:63] op_sel_hi:[1,0,1]
    v_pk_fma_f32 v[30:31], v[60:61], v[166:167], v[30:31] op_sel:[0,1,0] op_sel_hi:[1,1,1] neg_lo:[0,1,0] neg_hi:[0,1,0]
    v_pk_fma_f32 v[62:63], v[28:29], v[166:167], v[62:63] op_sel:[0,1,0] op_sel_hi:[1,1,1]
    v_pk_fma_f32 v[32:33], v[30:31], v[166:167], v[32:33] op_sel_hi:[1,0,1]
    v_pk_fma_f32 v[64:65], v[62:63], v[166:167], v[64:65] op_sel_hi:[1,0,1]
    v_pk_fma_f32 v[32:33], v[62:63], v[166:167], v[32:33] op_sel:[0,1,0] op_sel_hi:[1,1,1] neg_lo:[0,1,0] neg_hi:[0,1,0]
    v_pk_fma_f32 v[64:65], v[30:31], v[166:167], v[64:65] op_sel:[0,1,0] op_sel_hi:[1,1,1]
    v_cvt_pk_bf16_f32 v80, v16, v18
    v_cvt_pk_bf16_f32 v81, v20, v22
    v_cvt_pk_bf16_f32 v82, v24, v26
    v_cvt_pk_bf16_f32 v83, v28, v30
    ds_write_b128 v12, v[80:83] offset:0
    v_cvt_pk_bf16_f32 v88, v17, v19
    v_cvt_pk_bf16_f32 v89, v21, v23
    v_cvt_pk_bf16_f32 v90, v25, v27
    v_cvt_pk_bf16_f32 v91, v29, v31
    ds_write_b128 v214, v[88:91] offset:0
    v_cvt_pk_bf16_f32 v96, -v48, -v50
    v_cvt_pk_bf16_f32 v97, -v52, -v54
    v_cvt_pk_bf16_f32 v98, -v56, -v58
    v_cvt_pk_bf16_f32 v99, -v60, -v62
    ds_write_b128 v12, v[96:99] offset:4096
    v_cvt_pk_bf16_f32 v104, -v49, -v51
    v_cvt_pk_bf16_f32 v105, -v53, -v55
    v_cvt_pk_bf16_f32 v106, -v57, -v59
    v_cvt_pk_bf16_f32 v107, -v61, -v63
    ds_write_b128 v214, v[104:107] offset:4096
    v_pk_fma_f32 v[34:35], v[32:33], v[166:167], v[34:35] op_sel_hi:[1,0,1]
    v_pk_fma_f32 v[66:67], v[64:65], v[166:167], v[66:67] op_sel_hi:[1,0,1]
    v_pk_fma_f32 v[34:35], v[64:65], v[166:167], v[34:35] op_sel:[0,1,0] op_sel_hi:[1,1,1] neg_lo:[0,1,0] neg_hi:[0,1,0]
    v_pk_fma_f32 v[66:67], v[32:33], v[166:167], v[66:67] op_sel:[0,1,0] op_sel_hi:[1,1,1]
    v_pk_fma_f32 v[36:37], v[34:35], v[166:167], v[36:37] op_sel_hi:[1,0,1]
    v_pk_fma_f32 v[68:69], v[66:67], v[166:167], v[68:69] op_sel_hi:[1,0,1]
    v_pk_fma_f32 v[36:37], v[66:67], v[166:167], v[36:37] op_sel:[0,1,0] op_sel_hi:[1,1,1] neg_lo:[0,1,0] neg_hi:[0,1,0]
    v_pk_fma_f32 v[68:69], v[34:35], v[166:167], v[68:69] op_sel:[0,1,0] op_sel_hi:[1,1,1]
    v_pk_fma_f32 v[38:39], v[36:37], v[166:167], v[38:39] op_sel_hi:[1,0,1]
    v_pk_fma_f32 v[70:71], v[68:69], v[166:167], v[70:71] op_sel_hi:[1,0,1]
    v_pk_fma_f32 v[38:39], v[68:69], v[166:167], v[38:39] op_sel:[0,1,0] op_sel_hi:[1,1,1] neg_lo:[0,1,0] neg_hi:[0,1,0]
    v_pk_fma_f32 v[70:71], v[36:37], v[166:167], v[70:71] op_sel:[0,1,0] op_sel_hi:[1,1,1]
    v_pk_fma_f32 v[40:41], v[38:39], v[166:167], v[40:41] op_sel_hi:[1,0,1]
    v_pk_fma_f32 v[72:73], v[70:71], v[166:167], v[72:73] op_sel_hi:[1,0,1]
    v_pk_fma_f32 v[40:41], v[70:71], v[166:167], v[40:41] op_sel:[0,1,0] op_sel_hi:[1,1,1] neg_lo:[0,1,0] neg_hi:[0,1,0]
    v_pk_fma_f32 v[72:73], v[38:39], v[166:167], v[72:73] op_sel:[0,1,0] op_sel_hi:[1,1,1]
    v_pk_fma_f32 v[42:43], v[40:41], v[166:167], v[42:43] op_sel_hi:[1,0,1]
    v_pk_fma_f32 v[74:75], v[72:73], v[166:167], v[74:75] op_sel_hi:[1,0,1]
    v_pk_fma_f32 v[42:43], v[72:73], v[166:167], v[42:43] op_sel:[0,1,0] op_sel_hi:[1,1,1] neg_lo:[0,1,0] neg_hi:[0,1,0]
    v_pk_fma_f32 v[74:75], v[40:41], v[166:167], v[74:75] op_sel:[0,1,0] op_sel_hi:[1,1,1]
    v_pk_fma_f32 v[44:45], v[42:43], v[166:167], v[44:45] op_sel_hi:[1,0,1]
    v_pk_fma_f32 v[76:77], v[74:75], v[166:167], v[76:77] op_sel_hi:[1,0,1]
    v_pk_fma_f32 v[44:45], v[74:75], v[166:167], v[44:45] op_sel:[0,1,0] op_sel_hi:[1,1,1] neg_lo:[0,1,0] neg_hi:[0,1,0]
    v_pk_fma_f32 v[76:77], v[42:43], v[166:167], v[76:77] op_sel:[0,1,0] op_sel_hi:[1,1,1]
    v_pk_fma_f32 v[46:47], v[44:45], v[166:167], v[46:47] op_sel_hi:[1,0,1]
    v_pk_fma_f32 v[78:79], v[76:77], v[166:167], v[78:79] op_sel_hi:[1,0,1]
    v_pk_fma_f32 v[46:47], v[76:77], v[166:167], v[46:47] op_sel:[0,1,0] op_sel_hi:[1,1,1] neg_lo:[0,1,0] neg_hi:[0,1,0]
    v_pk_fma_f32 v[78:79], v[44:45], v[166:167], v[78:79] op_sel:[0,1,0] op_sel_hi:[1,1,1]
    v_cvt_pk_bf16_f32 v84, v32, v34
    v_cvt_pk_bf16_f32 v85, v36, v38
    v_cvt_pk_bf16_f32 v86, v40, v42
    v_cvt_pk_bf16_f32 v87, v44, v46
    ds_write_b128 v213, v[84:87] offset:0
    v_cvt_pk_bf16_f32 v92, v33, v35
    v_cvt_pk_bf16_f32 v93, v37, v39
    v_cvt_pk_bf16_f32 v94, v41, v43
    v_cvt_pk_bf16_f32 v95, v45, v47
    ds_write_b128 v215, v[92:95] offset:0
    v_cvt_pk_bf16_f32 v100, -v64, -v66
    v_cvt_pk_bf16_f32 v101, -v68, -v70
    v_cvt_pk_bf16_f32 v102, -v72, -v74
    v_cvt_pk_bf16_f32 v103, -v76, -v78
    ds_write_b128 v213, v[100:103] offset:4096
    v_cvt_pk_bf16_f32 v108, -v65, -v67
    v_cvt_pk_bf16_f32 v109, -v69, -v71
    v_cvt_pk_bf16_f32 v110, -v73, -v75
    v_cvt_pk_bf16_f32 v111, -v77, -v79
    ds_write_b128 v215, v[108:111] offset:4096
    s_lshl_b32 s64, s37, 8
    s_lshl_b32 s65, s38, 3
    s_add_u32 s64, s64, s65
    s_lshl_b32 s65, s3, 1
    s_add_u32 s64, s64, s65
    s_lshl_b32 s64, s64, 10
    s_add_u32 s64, s64, 2097152
    v_lshlrev_b32 v12, 4, v0
    s_waitcnt lgkmcnt(0)
    ds_read_b64_tr_b16 v[16:17], v13 offset:0
    ds_read_b64_tr_b16 v[18:19], v13 offset:1088
    ds_read_b64_tr_b16 v[20:21], v13 offset:2176
    ds_read_b64_tr_b16 v[22:23], v13 offset:3264
    ds_read_b64_tr_b16 v[24:25], v13 offset:64
    ds_read_b64_tr_b16 v[26:27], v13 offset:1024
    ds_read_b64_tr_b16 v[28:29], v13 offset:2240
    ds_read_b64_tr_b16 v[30:31], v13 offset:3200
    ds_read_b64_tr_b16 v[32:33], v13 offset:128
    ds_read_b64_tr_b16 v[34:35], v13 offset:1216
    ds_read_b64_tr_b16 v[36:37], v13 offset:2048
    ds_read_b64_tr_b16 v[38:39], v13 offset:3136
    ds_read_b64_tr_b16 v[40:41], v13 offset:192
    ds_read_b64_tr_b16 v[42:43], v13 offset:1152
    ds_read_b64_tr_b16 v[44:45], v13 offset:2112
    ds_read_b64_tr_b16 v[46:47], v13 offset:3072
    s_cmp_eq_u32 s73, 1
    s_cbranch_scc1 concat_heads__linear_attn_block__ssm_conv_s5__prompt_kernel_h_fast
    s_mov_b32 s65, s64
    s_waitcnt lgkmcnt(12)
    buffer_store_dwordx4 v[16:19], v12, s[48:51], s65 offen offset:0 sc1
    buffer_store_dwordx4 v[20:23], v12, s[48:51], s65 offen offset:1024 sc1
    s_add_u32 s65, s65, 0x10000
    s_waitcnt lgkmcnt(8)
    buffer_store_dwordx4 v[24:27], v12, s[48:51], s65 offen offset:0 sc1
    buffer_store_dwordx4 v[28:31], v12, s[48:51], s65 offen offset:1024 sc1
    s_add_u32 s65, s65, 0x10000
    s_waitcnt lgkmcnt(4)
    buffer_store_dwordx4 v[32:35], v12, s[48:51], s65 offen offset:0 sc1
    buffer_store_dwordx4 v[36:39], v12, s[48:51], s65 offen offset:1024 sc1
    s_add_u32 s65, s65, 0x10000
    s_waitcnt lgkmcnt(0)
    buffer_store_dwordx4 v[40:43], v12, s[48:51], s65 offen offset:0 sc1
    buffer_store_dwordx4 v[44:47], v12, s[48:51], s65 offen offset:1024 sc1
    s_branch concat_heads__linear_attn_block__ssm_conv_s5__prompt_kernel_h_j
concat_heads__linear_attn_block__ssm_conv_s5__prompt_kernel_h_fast:
    s_mov_b32 s65, s64
    s_waitcnt lgkmcnt(12)
    buffer_store_dwordx4 v[16:19], v12, s[48:51], s65 offen offset:0 nt
    buffer_store_dwordx4 v[20:23], v12, s[48:51], s65 offen offset:1024 nt
    s_add_u32 s65, s65, 0x10000
    s_waitcnt lgkmcnt(8)
    buffer_store_dwordx4 v[24:27], v12, s[48:51], s65 offen offset:0 nt
    buffer_store_dwordx4 v[28:31], v12, s[48:51], s65 offen offset:1024 nt
    s_add_u32 s65, s65, 0x10000
    s_waitcnt lgkmcnt(4)
    buffer_store_dwordx4 v[32:35], v12, s[48:51], s65 offen offset:0 nt
    buffer_store_dwordx4 v[36:39], v12, s[48:51], s65 offen offset:1024 nt
    s_add_u32 s65, s65, 0x10000
    s_waitcnt lgkmcnt(0)
    buffer_store_dwordx4 v[40:43], v12, s[48:51], s65 offen offset:0 nt
    buffer_store_dwordx4 v[44:47], v12, s[48:51], s65 offen offset:1024 nt
concat_heads__linear_attn_block__ssm_conv_s5__prompt_kernel_h_j:
    v_readfirstlane_b32 s78, v230
    v_readfirstlane_b32 s79, v231
    s_barrier
    s_waitcnt vmcnt(0)
    s_add_u32 s64, s37, 16
    s_lshl_b32 s64, s64, 10
    s_add_u32 s64, s64, 7602176
    s_lshl_b32 s65, s38, 7
    s_add_u32 s64, s64, s65
    s_lshl_b32 s65, s3, 3
    s_add_u32 s64, s64, s65
    v_mov_b32 v12, 0
    s_mov_b64 s[74:75], exec
    s_mov_b64 exec, 1
    s_cmp_eq_u32 s73, 1
    s_cbranch_scc1 concat_heads__linear_attn_block__ssm_conv_s5__prompt_kernel_wf_fast_B
    buffer_store_dwordx2 v[230:231], v12, s[48:51], s64 offen sc1
    s_branch concat_heads__linear_attn_block__ssm_conv_s5__prompt_kernel_wf_j_B
concat_heads__linear_attn_block__ssm_conv_s5__prompt_kernel_wf_fast_B:
    buffer_store_dwordx2 v[230:231], v12, s[48:51], s64 offen
concat_heads__linear_attn_block__ssm_conv_s5__prompt_kernel_wf_j_B:
    s_mov_b64 exec, s[74:75]
    s_branch concat_heads__linear_attn_block__ssm_conv_s5__prompt_kernel_p2B
concat_heads__linear_attn_block__ssm_conv_s5__prompt_kernel_end:
    s_endpgm
.section .rodata,"a"
.p2align 6
.amdhsa_kernel concat_heads__linear_attn_block__ssm_conv_s5__prompt_kernel
  .amdhsa_next_free_vgpr 256
  .amdhsa_next_free_sgpr 102
  .amdhsa_accum_offset 256
  .amdhsa_group_segment_fixed_size 0
  .amdhsa_kernarg_size 120
  .amdhsa_user_sgpr_count 2
  .amdhsa_user_sgpr_kernarg_segment_ptr 1
  .amdhsa_system_sgpr_workgroup_id_x 1
  .amdhsa_float_denorm_mode_32 3
.end_amdhsa_kernel
```
